```python
import torch

def _softmax(x, axis=-1):
    return torch.softmax(x, dim=axis)
def _gelu(x):
    return torch.nn.functional.gelu(x, approximate="tanh")
def _silu(x):
    return torch.nn.functional.silu(x)
def _sigmoid(x):
    return torch.sigmoid(x)
def _layernorm(x, axis=-1, eps=1e-5):
    m = x.mean(dim=axis, keepdim=True)
    v = x.var(dim=axis, keepdim=True, unbiased=False)
    return (x - m) / torch.sqrt(v + eps)
def _scatter_add(tgt, idx, src, axis=0):
    return tgt.clone().index_add_(axis, idx, src)
def _segment_sum(src, seg, n):
    out = torch.zeros((n,) + src.shape[1:], dtype=src.dtype)
    return out.index_add_(0, seg, src)
def _pad(x, pw):
    flat = tuple(v for pair in reversed(pw) for v in pair)
    return torch.nn.functional.pad(x, flat)

kernel_name = 'standalone__gqa_block_cached__near_ridge'

def setup_inputs():

    _w = (lambda a: (lambda t: t.to(torch.bfloat16) if t.is_floating_point() else t)(torch.as_tensor(a)))
    B, Sq, D = 16, 96, 448
    Hq, Hkv, Sk, Dh = 16, 8, 512, 256
    assert Hq % Hkv == 0, (Hq, Hkv)
    return {
        "x": _w((lambda *s: torch.randn(*s, dtype=torch.bfloat16) * 0.8)(B, Sq, D)),
        "k_cache": _w((lambda *s: torch.randn(*s, dtype=torch.bfloat16) * 0.8)(B, Hkv, Sk, Dh)),
        "v_cache": _w((lambda *s: torch.randn(*s, dtype=torch.bfloat16) * 0.05)(B, Hkv, Sk, Dh)),
        "wq": _w((lambda *s: torch.randn(*s, dtype=torch.bfloat16) * 0.8)(D, Hq * Dh) * (D ** -0.5)),
        "wo": _w((lambda *s: torch.randn(*s, dtype=torch.bfloat16) * 0.05)(Hq * Dh, D) * ((Hq * Dh) ** -0.5)),
    }

def reference(x, k_cache, v_cache, wq, wo):
    B, Sq, D = x.shape
    Hq, Dh = 16, 256
    Hkv = k_cache.shape[1]
    rep = Hq // Hkv
    q = (lambda x, *d: x.permute(*d))((x @ wq).reshape(B, Sq, Hq, Dh), 0, 2, 1, 3)
    k = (lambda x, n, axis: torch.repeat_interleave(x, n, dim=axis))(k_cache, rep, axis=1)
    v = (lambda x, n, axis: torch.repeat_interleave(x, n, dim=axis))(v_cache, rep, axis=1)
    scores = torch.einsum("bhqd,bhkd->bhqk", q, k) * (Dh ** -0.5)
    p = _softmax(scores, axis=-1)
    o = torch.einsum("bhqk,bhkd->bhqd", p, v)
    return (lambda x, *d: x.permute(*d))(o, 0, 2, 1, 3).reshape(B, Sq, Hq * Dh) @ wo
```

```asm
; @launch grid=(256,1,1) block=(256,1,1) lds=163840
.amdgcn_target "amdgcn-amd-amdhsa--gfx950"
.text
.globl standalone__gqa_block_cached__near_ridge_kernel
.p2align 8
.type standalone__gqa_block_cached__near_ridge_kernel,@function
standalone__gqa_block_cached__near_ridge_kernel:
    s_cmp_ge_u32 s2, 256
    s_cbranch_scc1 L_end
    s_load_dwordx16 s[4:19], s[0:1], 0
    s_lshr_b32 s57, s2, 3
    s_lshr_b32 s59, s2, 3
    s_getpc_b64 s[70:71]
L_pc:
    v_and_b32 v62, 7, v0
    s_lshl_b32 s59, s59, 10
    v_lshlrev_b32 v62, 7, v62
    s_sub_u32 s70, s70, L_pc-standalone__gqa_block_cached__near_ridge_kernel
    s_subb_u32 s71, s71, 0
    v_add_u32 v62, s59, v62
    v_min_u32 v62, L_end-standalone__gqa_block_cached__near_ridge_kernel, v62
    global_load_dword v63, v62, s[70:71]
    s_and_b32 s56, s2, 7
    v_and_b32 v1, 63, v0
    v_lshrrev_b32 v48, 6, v0
    s_and_b32 s50, s56, 3
    s_lshl_b32 s50, s50, 2
    v_readfirstlane_b32 s48, v48
    s_and_b32 s58, s57, 3
    s_or_b32 s50, s50, s58
    s_lshr_b32 s49, s56, 2
    s_lshl_b32 s49, s49, 3
    s_lshr_b32 s59, s57, 2
    s_or_b32 s49, s49, s59
    s_lshl_b32 s58, s58, 1
    s_add_u32 s54, s59, s58
    s_cmp_ge_u32 s54, 7
    s_cselect_b32 s56, 7, 0
    s_sub_u32 s54, s54, s56
    s_lshl_b32 s62, s54, 7
    v_lshrrev_b32 v48, 3, v1
    v_lshrrev_b32 v49, 4, v1
    v_and_b32 v50, 7, v1
    v_xor_b32 v51, v50, v49
    s_and_b32 s56, s48, 1
    s_lshl_b32 s56, s56, 2
    v_mul_u32_u24 v52, 896, v48
    v_xor_b32 v51, s56, v51
    v_lshl_add_u32 v12, v51, 4, v52
    v_xor_b32 v51, 4, v51
    v_lshl_add_u32 v13, v51, 4, v52
    v_add_u32 v14, 12288, v12
    v_add_u32 v13, 6144, v13
    v_and_b32 v53, 1, v49
    v_lshlrev_b32 v53, 2, v53
    v_xor_b32 v53, v50, v53
    v_lshlrev_b32 v54, 13, v48
    v_lshl_add_u32 v16, v53, 4, v54
    v_add_u32 v17, 64512, v16
    s_mul_i32 s55, s48, 21504
    s_mul_i32 s69, s48, 3072
    s_lshl_b32 s52, s48, 14
    s_add_u32 s52, s52, 98304
    s_lshl_b32 s56, s50, 9
    s_lshl_b32 s57, s48, 7
    s_add_u32 s56, s56, s57
    s_mul_i32 s57, s49, 86016
    s_mov_b32 s22, 86016
    s_mov_b32 s23, 0x20000
    s_mov_b32 s27, 0x20000
    s_sub_u32 s26, 3670016, s56
    s_waitcnt lgkmcnt(0)
    s_add_u32 s20, s4, s57
    s_addc_u32 s21, s5, 0
    s_add_u32 s24, s10, s56
    s_addc_u32 s25, s11, 0
    s_add_u32 m0, s52, 0
    s_lshl_b32 s61, s62, 12
    buffer_load_dwordx4 v16, s[24:27], s61 offen offset:0  lds
    buffer_load_dwordx4 v17, s[24:27], s61 offen offset:1024  lds
    s_add_u32 m0, s69, 0
    s_add_u32 s61, s55, s62
    buffer_load_dwordx4 v12, s[20:23], s61 offen offset:0  lds
    buffer_load_dwordx4 v13, s[20:23], s61 offen offset:1024  lds
    buffer_load_dwordx4 v14, s[20:23], s61 offen offset:2048  lds
    s_add_u32 m0, s52, 2048
    s_lshl_b32 s61, s62, 12
    s_add_u32 s61, s61, 131072
    buffer_load_dwordx4 v16, s[24:27], s61 offen offset:0  lds
    buffer_load_dwordx4 v17, s[24:27], s61 offen offset:1024  lds
    s_lshl_b32 s58, s54, 2
    s_mov_b32 s96, 0x06543210
    s_mov_b32 s97, 0
    s_lshl_b64 s[96:97], s[96:97], 28
    s_or_b32 s96, s96, 0x06543210
    s_lshr_b64 s[96:97], s[96:97], s58
    s_bfe_u32 s56, s96, 0x40004
    s_lshl_b32 s63, s56, 7
    s_bfe_u32 s56, s96, 0x40008
    s_lshl_b32 s64, s56, 7
    s_bfe_u32 s56, s96, 0x4000c
    s_lshl_b32 s65, s56, 7
    s_bfe_u32 s56, s96, 0x40010
    s_lshl_b32 s66, s56, 7
    s_bfe_u32 s56, s96, 0x40014
    s_lshl_b32 s67, s56, 7
    s_bfe_u32 s56, s96, 0x40018
    s_lshl_b32 s68, s56, 7
    v_lshlrev_b32 v2, 4, v1
    v_add_u32 v3, 36864, v2
    v_and_b32 v55, 31, v1
    v_lshrrev_b32 v56, 5, v1
    v_lshrrev_b32 v57, 3, v55
    v_lshlrev_b32 v57, 10, v57
    v_and_b32 v58, 7, v55
    v_lshl_add_u32 v57, v58, 7, v57
    v_bfe_u32 v58, v55, 1, 3
    v_add_u32 v59, 0, v56
    v_xor_b32 v59, v59, v58
    v_lshl_add_u32 v4, v59, 4, v57
    v_add_u32 v59, 2, v56
    v_xor_b32 v59, v59, v58
    v_lshl_add_u32 v5, v59, 4, v57
    v_add_u32 v59, 4, v56
    v_xor_b32 v59, v59, v58
    v_lshl_add_u32 v6, v59, 4, v57
    v_add_u32 v59, 6, v56
    v_xor_b32 v59, v59, v58
    v_lshl_add_u32 v7, v59, 4, v57
    v_bfe_u32 v48, v1, 2, 2
    v_and_b32 v49, 3, v1
    v_bfe_u32 v50, v1, 4, 1
    v_and_b32 v51, 1, v49
    v_lshrrev_b32 v52, 1, v49
    v_lshl_add_u32 v53, v50, 1, v51
    v_lshrrev_b32 v54, 1, v48
    v_lshlrev_b32 v54, 2, v54
    v_xor_b32 v53, v53, v54
    v_lshl_add_u32 v55, v56, 3, v48
    v_lshlrev_b32 v55, 7, v55
    v_lshl_add_u32 v55, v53, 4, v55
    v_lshl_add_u32 v55, v52, 3, v55
    v_add_u32 v18, s52, v55
    v_xor_b32 v19, 64, v18
    s_add_u32 m0, s52, 4096
    s_lshl_b32 s61, s62, 12
    s_add_u32 s61, s61, 262144
    buffer_load_dwordx4 v16, s[24:27], s61 offen offset:0  lds
    buffer_load_dwordx4 v17, s[24:27], s61 offen offset:1024  lds
    s_add_u32 m0, s52, 6144
    s_lshl_b32 s61, s62, 12
    s_add_u32 s61, s61, 393216
    buffer_load_dwordx4 v16, s[24:27], s61 offen offset:0  lds
    buffer_load_dwordx4 v17, s[24:27], s61 offen offset:1024  lds
    s_add_u32 m0, s69, 12288
    s_add_u32 s61, s55, s63
    buffer_load_dwordx4 v12, s[20:23], s61 offen offset:0  lds
    buffer_load_dwordx4 v13, s[20:23], s61 offen offset:1024  lds
    buffer_load_dwordx4 v14, s[20:23], s61 offen offset:2048  lds
    s_waitcnt vmcnt(9)
    s_barrier
    ds_read_b64_tr_b16 a[0:1], v18 offset:0
    ds_read_b64_tr_b16 a[2:3], v18 offset:512
    ds_read_b64_tr_b16 a[4:5], v19 offset:0
    ds_read_b64_tr_b16 a[6:7], v19 offset:512
    ds_read_b128 a[8:11], v4 offset:0
    ds_read_b128 a[12:15], v4 offset:4096
    ds_read_b128 a[16:19], v4 offset:8192
    s_waitcnt lgkmcnt(0)
    v_mfma_f32_32x32x16_bf16 v[64:79], a[0:3], a[8:11], 0
    s_add_u32 m0, s52, 8192
    s_lshl_b32 s61, s63, 12
    buffer_load_dwordx4 v16, s[24:27], s61 offen offset:0  lds
    s_waitcnt vmcnt(8)
    ds_read_b64_tr_b16 a[20:21], v18 offset:2048
    ds_read_b64_tr_b16 a[22:23], v18 offset:2560
    ds_read_b64_tr_b16 a[24:25], v19 offset:2048
    ds_read_b64_tr_b16 a[26:27], v19 offset:2560
    ds_read_b128 a[28:31], v5 offset:0
    v_mfma_f32_32x32x16_bf16 v[80:95], a[0:3], a[12:15], 0
    ds_read_b128 a[32:35], v5 offset:4096
    ds_read_b128 a[36:39], v5 offset:8192
    s_lshr_b32 s51, s50, 1
    v_add_u32 v8, 49152, v4
    v_add_u32 v9, 49152, v5
    v_mfma_f32_32x32x16_bf16 v[96:111], a[0:3], a[16:19], 0
    buffer_load_dwordx4 v17, s[24:27], s61 offen offset:1024  lds
    v_add_u32 v10, 49152, v6
    v_add_u32 v11, 49152, v7
    s_lshl_b32 s56, s49, 3
    s_add_u32 s56, s56, s51
    v_mfma_f32_32x32x16_bf16 v[112:127], a[4:7], a[8:11], 0
    s_lshl_b32 s56, s56, 18
    s_add_u32 s28, s6, s56
    s_addc_u32 s29, s7, 0
    s_mov_b32 s30, 262144
    s_mov_b32 s31, 0x20000
    v_mfma_f32_32x32x16_bf16 v[128:143], a[4:7], a[12:15], 0
    s_add_u32 m0, s52, 10240
    s_lshl_b32 s61, s63, 12
    s_add_u32 s61, s61, 131072
    buffer_load_dwordx4 v16, s[24:27], s61 offen offset:0  lds
    v_mfma_f32_32x32x16_bf16 v[144:159], a[4:7], a[16:19], 0
    s_add_u32 s32, s8, s56
    s_addc_u32 s33, s9, 0
    s_mov_b32 s34, 262144
    s_mov_b32 s35, 0x20000
    s_mul_i32 s56, s50, 229376
    s_waitcnt lgkmcnt(0)
    v_mfma_f32_32x32x16_bf16 v[64:79], a[20:23], a[28:31], v[64:79]
    buffer_load_dwordx4 v17, s[24:27], s61 offen offset:1024  lds
    s_waitcnt vmcnt(9)
    ds_read_b64_tr_b16 a[40:41], v18 offset:4096
    ds_read_b64_tr_b16 a[42:43], v18 offset:4608
    ds_read_b64_tr_b16 a[44:45], v19 offset:4096
    ds_read_b64_tr_b16 a[46:47], v19 offset:4608
    ds_read_b128 a[48:51], v6 offset:0
    v_mfma_f32_32x32x16_bf16 v[80:95], a[20:23], a[32:35], v[80:95]
    ds_read_b128 a[52:55], v6 offset:4096
    ds_read_b128 a[56:59], v6 offset:8192
    s_add_u32 s36, s12, s56
    s_addc_u32 s37, s13, 0
    s_mov_b32 s38, 229376
    v_mfma_f32_32x32x16_bf16 v[96:111], a[20:23], a[36:39], v[96:111]
    s_add_u32 m0, s52, 12288
    s_lshl_b32 s61, s63, 12
    s_add_u32 s61, s61, 262144
    buffer_load_dwordx4 v16, s[24:27], s61 offen offset:0  lds
    s_mov_b32 s39, 0x20000
    v_mfma_f32_32x32x16_bf16 v[112:127], a[24:27], a[28:31], v[112:127]
    s_mov_b32 s40, s18
    s_mov_b32 s41, s19
    s_mov_b32 s42, 0x10000000
    s_mov_b32 s43, 0x20000
    s_mov_b32 s44, s14
    v_mfma_f32_32x32x16_bf16 v[128:143], a[24:27], a[32:35], v[128:143]
    buffer_load_dwordx4 v17, s[24:27], s61 offen offset:1024  lds
    s_mov_b32 s45, s15
    s_mov_b32 s46, 1376256
    s_mov_b32 s47, 0x20000
    s_lshl_b32 s53, s48, 13
    v_mfma_f32_32x32x16_bf16 v[144:159], a[24:27], a[36:39], v[144:159]
    s_add_u32 s53, s53, 0
    s_mov_b32 s60, 0x3db8aa3b
    s_waitcnt lgkmcnt(0)
    v_mfma_f32_32x32x16_bf16 v[64:79], a[40:43], a[48:51], v[64:79]
    s_add_u32 m0, s52, 14336
    s_lshl_b32 s61, s63, 12
    s_add_u32 s61, s61, 393216
    buffer_load_dwordx4 v16, s[24:27], s61 offen offset:0  lds
    s_waitcnt vmcnt(10)
    ds_read_b64_tr_b16 a[60:61], v18 offset:6144
    ds_read_b64_tr_b16 a[62:63], v18 offset:6656
    ds_read_b64_tr_b16 a[64:65], v19 offset:6144
    ds_read_b64_tr_b16 a[66:67], v19 offset:6656
    ds_read_b128 a[68:71], v7 offset:0
    v_mfma_f32_32x32x16_bf16 v[80:95], a[40:43], a[52:55], v[80:95]
    ds_read_b128 a[72:75], v7 offset:4096
    ds_read_b128 a[76:79], v7 offset:8192
    v_mfma_f32_32x32x16_bf16 v[96:111], a[40:43], a[56:59], v[96:111]
    buffer_load_dwordx4 v17, s[24:27], s61 offen offset:1024  lds
    v_mfma_f32_32x32x16_bf16 v[112:127], a[44:47], a[48:51], v[112:127]
    v_mfma_f32_32x32x16_bf16 v[128:143], a[44:47], a[52:55], v[128:143]
    s_add_u32 m0, s69, 24576
    s_add_u32 s61, s55, s64
    buffer_load_dwordx4 v12, s[20:23], s61 offen offset:0  lds
    v_mfma_f32_32x32x16_bf16 v[144:159], a[44:47], a[56:59], v[144:159]
    s_waitcnt lgkmcnt(0)
    v_mfma_f32_32x32x16_bf16 v[64:79], a[60:63], a[68:71], v[64:79]
    buffer_load_dwordx4 v13, s[20:23], s61 offen offset:1024  lds
    s_waitcnt vmcnt(8)
    s_barrier
    ds_read_b64_tr_b16 a[0:1], v18 offset:8192
    ds_read_b64_tr_b16 a[2:3], v18 offset:8704
    ds_read_b64_tr_b16 a[4:5], v19 offset:8192
    ds_read_b64_tr_b16 a[6:7], v19 offset:8704
    ds_read_b128 a[8:11], v4 offset:12288
    v_mfma_f32_32x32x16_bf16 v[80:95], a[60:63], a[72:75], v[80:95]
    ds_read_b128 a[12:15], v4 offset:16384
    ds_read_b128 a[16:19], v4 offset:20480
    v_mfma_f32_32x32x16_bf16 v[96:111], a[60:63], a[76:79], v[96:111]
    buffer_load_dwordx4 v14, s[20:23], s61 offen offset:2048  lds
    v_mfma_f32_32x32x16_bf16 v[112:127], a[64:67], a[68:71], v[112:127]
    v_mfma_f32_32x32x16_bf16 v[128:143], a[64:67], a[72:75], v[128:143]
    s_add_u32 m0, s52, 0
    s_lshl_b32 s61, s64, 12
    buffer_load_dwordx4 v16, s[24:27], s61 offen offset:0  lds
    v_mfma_f32_32x32x16_bf16 v[144:159], a[64:67], a[76:79], v[144:159]
    s_waitcnt lgkmcnt(0)
    v_mfma_f32_32x32x16_bf16 v[64:79], a[0:3], a[8:11], v[64:79]
    buffer_load_dwordx4 v17, s[24:27], s61 offen offset:1024  lds
    s_waitcnt vmcnt(9)
    ds_read_b64_tr_b16 a[20:21], v18 offset:10240
    ds_read_b64_tr_b16 a[22:23], v18 offset:10752
    ds_read_b64_tr_b16 a[24:25], v19 offset:10240
    ds_read_b64_tr_b16 a[26:27], v19 offset:10752
    ds_read_b128 a[28:31], v5 offset:12288
    v_mfma_f32_32x32x16_bf16 v[80:95], a[0:3], a[12:15], v[80:95]
    ds_read_b128 a[32:35], v5 offset:16384
    ds_read_b128 a[36:39], v5 offset:20480
    v_mfma_f32_32x32x16_bf16 v[96:111], a[0:3], a[16:19], v[96:111]
    s_add_u32 m0, s52, 2048
    s_lshl_b32 s61, s64, 12
    s_add_u32 s61, s61, 131072
    buffer_load_dwordx4 v16, s[24:27], s61 offen offset:0  lds
    v_mfma_f32_32x32x16_bf16 v[112:127], a[4:7], a[8:11], v[112:127]
    v_mfma_f32_32x32x16_bf16 v[128:143], a[4:7], a[12:15], v[128:143]
    buffer_load_dwordx4 v17, s[24:27], s61 offen offset:1024  lds
    v_mfma_f32_32x32x16_bf16 v[144:159], a[4:7], a[16:19], v[144:159]
    s_waitcnt lgkmcnt(0)
    v_mfma_f32_32x32x16_bf16 v[64:79], a[20:23], a[28:31], v[64:79]
    s_add_u32 m0, s52, 4096
    s_lshl_b32 s61, s64, 12
    s_add_u32 s61, s61, 262144
    buffer_load_dwordx4 v16, s[24:27], s61 offen offset:0  lds
    s_waitcnt vmcnt(10)
    ds_read_b64_tr_b16 a[40:41], v18 offset:12288
    ds_read_b64_tr_b16 a[42:43], v18 offset:12800
    ds_read_b64_tr_b16 a[44:45], v19 offset:12288
    ds_read_b64_tr_b16 a[46:47], v19 offset:12800
    ds_read_b128 a[48:51], v6 offset:12288
    v_mfma_f32_32x32x16_bf16 v[80:95], a[20:23], a[32:35], v[80:95]
    ds_read_b128 a[52:55], v6 offset:16384
    ds_read_b128 a[56:59], v6 offset:20480
    v_mfma_f32_32x32x16_bf16 v[96:111], a[20:23], a[36:39], v[96:111]
    buffer_load_dwordx4 v17, s[24:27], s61 offen offset:1024  lds
    v_mfma_f32_32x32x16_bf16 v[112:127], a[24:27], a[28:31], v[112:127]
    v_mfma_f32_32x32x16_bf16 v[128:143], a[24:27], a[32:35], v[128:143]
    s_add_u32 m0, s52, 6144
    s_lshl_b32 s61, s64, 12
    s_add_u32 s61, s61, 393216
    buffer_load_dwordx4 v16, s[24:27], s61 offen offset:0  lds
    v_mfma_f32_32x32x16_bf16 v[144:159], a[24:27], a[36:39], v[144:159]
    s_waitcnt lgkmcnt(0)
    v_mfma_f32_32x32x16_bf16 v[64:79], a[40:43], a[48:51], v[64:79]
    buffer_load_dwordx4 v17, s[24:27], s61 offen offset:1024  lds
    s_waitcnt vmcnt(11)
    ds_read_b64_tr_b16 a[60:61], v18 offset:14336
    ds_read_b64_tr_b16 a[62:63], v18 offset:14848
    ds_read_b64_tr_b16 a[64:65], v19 offset:14336
    ds_read_b64_tr_b16 a[66:67], v19 offset:14848
    ds_read_b128 a[68:71], v7 offset:12288
    v_mfma_f32_32x32x16_bf16 v[80:95], a[40:43], a[52:55], v[80:95]
    ds_read_b128 a[72:75], v7 offset:16384
    ds_read_b128 a[76:79], v7 offset:20480
    v_mfma_f32_32x32x16_bf16 v[96:111], a[40:43], a[56:59], v[96:111]
    s_add_u32 m0, s69, 36864
    s_add_u32 s61, s55, s65
    buffer_load_dwordx4 v12, s[20:23], s61 offen offset:0  lds
    v_mfma_f32_32x32x16_bf16 v[112:127], a[44:47], a[48:51], v[112:127]
    v_mfma_f32_32x32x16_bf16 v[128:143], a[44:47], a[52:55], v[128:143]
    buffer_load_dwordx4 v13, s[20:23], s61 offen offset:1024  lds
    v_mfma_f32_32x32x16_bf16 v[144:159], a[44:47], a[56:59], v[144:159]
    s_waitcnt lgkmcnt(0)
    v_mfma_f32_32x32x16_bf16 v[64:79], a[60:63], a[68:71], v[64:79]
    buffer_load_dwordx4 v14, s[20:23], s61 offen offset:2048  lds
    s_waitcnt vmcnt(9)
    s_barrier
    ds_read_b64_tr_b16 a[0:1], v18 offset:0
    ds_read_b64_tr_b16 a[2:3], v18 offset:512
    ds_read_b64_tr_b16 a[4:5], v19 offset:0
    ds_read_b64_tr_b16 a[6:7], v19 offset:512
    ds_read_b128 a[8:11], v4 offset:24576
    v_mfma_f32_32x32x16_bf16 v[80:95], a[60:63], a[72:75], v[80:95]
    ds_read_b128 a[12:15], v4 offset:28672
    ds_read_b128 a[16:19], v4 offset:32768
    v_mfma_f32_32x32x16_bf16 v[96:111], a[60:63], a[76:79], v[96:111]
    s_add_u32 m0, s52, 8192
    s_lshl_b32 s61, s65, 12
    buffer_load_dwordx4 v16, s[24:27], s61 offen offset:0  lds
    v_mfma_f32_32x32x16_bf16 v[112:127], a[64:67], a[68:71], v[112:127]
    v_mfma_f32_32x32x16_bf16 v[128:143], a[64:67], a[72:75], v[128:143]
    buffer_load_dwordx4 v17, s[24:27], s61 offen offset:1024  lds
    v_mfma_f32_32x32x16_bf16 v[144:159], a[64:67], a[76:79], v[144:159]
    s_waitcnt lgkmcnt(0)
    v_mfma_f32_32x32x16_bf16 v[64:79], a[0:3], a[8:11], v[64:79]
    s_add_u32 m0, s52, 10240
    s_lshl_b32 s61, s65, 12
    s_add_u32 s61, s61, 131072
    buffer_load_dwordx4 v16, s[24:27], s61 offen offset:0  lds
    s_waitcnt vmcnt(10)
    ds_read_b64_tr_b16 a[20:21], v18 offset:2048
    ds_read_b64_tr_b16 a[22:23], v18 offset:2560
    ds_read_b64_tr_b16 a[24:25], v19 offset:2048
    ds_read_b64_tr_b16 a[26:27], v19 offset:2560
    ds_read_b128 a[28:31], v5 offset:24576
    v_mfma_f32_32x32x16_bf16 v[80:95], a[0:3], a[12:15], v[80:95]
    ds_read_b128 a[32:35], v5 offset:28672
    ds_read_b128 a[36:39], v5 offset:32768
    v_mfma_f32_32x32x16_bf16 v[96:111], a[0:3], a[16:19], v[96:111]
    buffer_load_dwordx4 v17, s[24:27], s61 offen offset:1024  lds
    v_mfma_f32_32x32x16_bf16 v[112:127], a[4:7], a[8:11], v[112:127]
    v_mfma_f32_32x32x16_bf16 v[128:143], a[4:7], a[12:15], v[128:143]
    s_add_u32 m0, s52, 12288
    s_lshl_b32 s61, s65, 12
    s_add_u32 s61, s61, 262144
    buffer_load_dwordx4 v16, s[24:27], s61 offen offset:0  lds
    v_mfma_f32_32x32x16_bf16 v[144:159], a[4:7], a[16:19], v[144:159]
    s_waitcnt lgkmcnt(0)
    v_mfma_f32_32x32x16_bf16 v[64:79], a[20:23], a[28:31], v[64:79]
    buffer_load_dwordx4 v17, s[24:27], s61 offen offset:1024  lds
    v_lshrrev_b32 v56, 3, v1
    s_waitcnt vmcnt(11)
    ds_read_b64_tr_b16 a[40:41], v18 offset:4096
    ds_read_b64_tr_b16 a[42:43], v18 offset:4608
    ds_read_b64_tr_b16 a[44:45], v19 offset:4096
    ds_read_b64_tr_b16 a[46:47], v19 offset:4608
    ds_read_b128 a[48:51], v6 offset:24576
    v_mfma_f32_32x32x16_bf16 v[80:95], a[20:23], a[32:35], v[80:95]
    v_lshrrev_b32 v57, 4, v1
    ds_read_b128 a[52:55], v6 offset:28672
    ds_read_b128 a[56:59], v6 offset:32768
    v_and_b32 v58, 7, v1
    v_xor_b32 v58, v58, v57
    v_mfma_f32_32x32x16_bf16 v[96:111], a[20:23], a[36:39], v[96:111]
    s_add_u32 m0, s52, 14336
    s_lshl_b32 s61, s65, 12
    s_add_u32 s61, s61, 393216
    buffer_load_dwordx4 v16, s[24:27], s61 offen offset:0  lds
    v_lshlrev_b32 v56, 9, v56
    v_mfma_f32_32x32x16_bf16 v[112:127], a[24:27], a[28:31], v[112:127]
    v_lshl_add_u32 v40, v58, 4, v56
    v_xor_b32 v58, 4, v58
    v_lshl_add_u32 v41, v58, 4, v56
    v_add_u32 v42, 6144, v40
    v_add_u32 v43, 9216, v41
    v_mfma_f32_32x32x16_bf16 v[128:143], a[24:27], a[32:35], v[128:143]
    buffer_load_dwordx4 v17, s[24:27], s61 offen offset:1024  lds
    v_add_u32 v41, 3072, v41
    s_lshl_b32 s3, s48, 16
    v_mfma_f32_32x32x16_bf16 v[144:159], a[24:27], a[36:39], v[144:159]
    s_cmp_eq_u32 s48, 0
    s_cselect_b32 s98, 1, 0
    s_mov_b32 s99, 0
    s_or_b32 s56, s48, s50
    s_cmp_eq_u32 s56, 0
    s_cselect_b32 s100, -1, 0
    s_mov_b32 s101, 0
    s_mul_i32 s56, s49, 8448
    s_add_u32 s56, s56, 33554432
    v_lshlrev_b32 v61, 4, v1
    v_mov_b32 v56, 0
    v_mov_b32 v57, 0
    v_mov_b32 v58, 0
    v_mov_b32 v59, 0
    s_mov_b32 exec_lo, s100
    s_mov_b32 exec_hi, s100
    buffer_store_dwordx4 v[56:59], v61, s[40:43], s56 offen sc1
    buffer_store_dwordx4 v[56:59], v61, s[40:43], s56 offen offset:1024 sc1
    s_mov_b64 exec, -1
    s_waitcnt lgkmcnt(0)
    v_mfma_f32_32x32x16_bf16 v[64:79], a[40:43], a[48:51], v[64:79]
    s_add_u32 m0, s69, 49152
    s_add_u32 s61, s55, s66
    buffer_load_dwordx4 v12, s[20:23], s61 offen offset:0  lds
    s_waitcnt vmcnt(14)
    ds_read_b64_tr_b16 a[60:61], v18 offset:6144
    ds_read_b64_tr_b16 a[62:63], v18 offset:6656
    ds_read_b64_tr_b16 a[64:65], v19 offset:6144
    ds_read_b64_tr_b16 a[66:67], v19 offset:6656
    ds_read_b128 a[68:71], v7 offset:24576
    v_mfma_f32_32x32x16_bf16 v[80:95], a[40:43], a[52:55], v[80:95]
    ds_read_b128 a[72:75], v7 offset:28672
    ds_read_b128 a[76:79], v7 offset:32768
    v_mfma_f32_32x32x16_bf16 v[96:111], a[40:43], a[56:59], v[96:111]
    buffer_load_dwordx4 v13, s[20:23], s61 offen offset:1024  lds
    v_mfma_f32_32x32x16_bf16 v[112:127], a[44:47], a[48:51], v[112:127]
    v_mfma_f32_32x32x16_bf16 v[128:143], a[44:47], a[52:55], v[128:143]
    buffer_load_dwordx4 v14, s[20:23], s61 offen offset:2048  lds
    v_mfma_f32_32x32x16_bf16 v[144:159], a[44:47], a[56:59], v[144:159]
    s_waitcnt lgkmcnt(0)
    v_mfma_f32_32x32x16_bf16 v[64:79], a[60:63], a[68:71], v[64:79]
    s_add_u32 m0, s52, 0
    s_lshl_b32 s61, s66, 12
    buffer_load_dwordx4 v16, s[24:27], s61 offen offset:0  lds
    s_waitcnt vmcnt(12)
    s_barrier
    ds_read_b64_tr_b16 a[0:1], v18 offset:8192
    ds_read_b64_tr_b16 a[2:3], v18 offset:8704
    ds_read_b64_tr_b16 a[4:5], v19 offset:8192
    ds_read_b64_tr_b16 a[6:7], v19 offset:8704
    ds_read_b128 a[8:11], v4 offset:36864
    v_mfma_f32_32x32x16_bf16 v[80:95], a[60:63], a[72:75], v[80:95]
    ds_read_b128 a[12:15], v4 offset:40960
    ds_read_b128 a[16:19], v4 offset:45056
    v_mfma_f32_32x32x16_bf16 v[96:111], a[60:63], a[76:79], v[96:111]
    buffer_load_dwordx4 v17, s[24:27], s61 offen offset:1024  lds
    v_mfma_f32_32x32x16_bf16 v[112:127], a[64:67], a[68:71], v[112:127]
    v_mfma_f32_32x32x16_bf16 v[128:143], a[64:67], a[72:75], v[128:143]
    s_add_u32 m0, s52, 2048
    s_lshl_b32 s61, s66, 12
    s_add_u32 s61, s61, 131072
    buffer_load_dwordx4 v16, s[24:27], s61 offen offset:0  lds
    v_mfma_f32_32x32x16_bf16 v[144:159], a[64:67], a[76:79], v[144:159]
    s_waitcnt lgkmcnt(0)
    v_mfma_f32_32x32x16_bf16 v[64:79], a[0:3], a[8:11], v[64:79]
    buffer_load_dwordx4 v17, s[24:27], s61 offen offset:1024  lds
    s_waitcnt vmcnt(13)
    ds_read_b64_tr_b16 a[20:21], v18 offset:10240
    ds_read_b64_tr_b16 a[22:23], v18 offset:10752
    ds_read_b64_tr_b16 a[24:25], v19 offset:10240
    ds_read_b64_tr_b16 a[26:27], v19 offset:10752
    ds_read_b128 a[28:31], v5 offset:36864
    v_mfma_f32_32x32x16_bf16 v[80:95], a[0:3], a[12:15], v[80:95]
    ds_read_b128 a[32:35], v5 offset:40960
    ds_read_b128 a[36:39], v5 offset:45056
    v_mfma_f32_32x32x16_bf16 v[96:111], a[0:3], a[16:19], v[96:111]
    s_add_u32 m0, s52, 4096
    s_lshl_b32 s61, s66, 12
    s_add_u32 s61, s61, 262144
    buffer_load_dwordx4 v16, s[24:27], s61 offen offset:0  lds
    v_mfma_f32_32x32x16_bf16 v[112:127], a[4:7], a[8:11], v[112:127]
    v_mfma_f32_32x32x16_bf16 v[128:143], a[4:7], a[12:15], v[128:143]
    buffer_load_dwordx4 v17, s[24:27], s61 offen offset:1024  lds
    v_mfma_f32_32x32x16_bf16 v[144:159], a[4:7], a[16:19], v[144:159]
    s_waitcnt lgkmcnt(0)
    v_mfma_f32_32x32x16_bf16 v[64:79], a[20:23], a[28:31], v[64:79]
    s_add_u32 m0, s52, 6144
    s_lshl_b32 s61, s66, 12
    s_add_u32 s61, s61, 393216
    buffer_load_dwordx4 v16, s[24:27], s61 offen offset:0  lds
    s_waitcnt vmcnt(14)
    ds_read_b64_tr_b16 a[40:41], v18 offset:12288
    ds_read_b64_tr_b16 a[42:43], v18 offset:12800
    ds_read_b64_tr_b16 a[44:45], v19 offset:12288
    ds_read_b64_tr_b16 a[46:47], v19 offset:12800
    ds_read_b128 a[48:51], v6 offset:36864
    v_mfma_f32_32x32x16_bf16 v[80:95], a[20:23], a[32:35], v[80:95]
    ds_read_b128 a[52:55], v6 offset:40960
    ds_read_b128 a[56:59], v6 offset:45056
    v_mfma_f32_32x32x16_bf16 v[96:111], a[20:23], a[36:39], v[96:111]
    buffer_load_dwordx4 v17, s[24:27], s61 offen offset:1024  lds
    v_mfma_f32_32x32x16_bf16 v[112:127], a[24:27], a[28:31], v[112:127]
    v_mfma_f32_32x32x16_bf16 v[128:143], a[24:27], a[32:35], v[128:143]
    s_add_u32 m0, s69, 61440
    s_add_u32 s61, s55, s67
    buffer_load_dwordx4 v12, s[20:23], s61 offen offset:0  lds
    v_mfma_f32_32x32x16_bf16 v[144:159], a[24:27], a[36:39], v[144:159]
    s_waitcnt lgkmcnt(0)
    v_mfma_f32_32x32x16_bf16 v[64:79], a[40:43], a[48:51], v[64:79]
    buffer_load_dwordx4 v13, s[20:23], s61 offen offset:1024  lds
    s_waitcnt vmcnt(15)
    ds_read_b64_tr_b16 a[60:61], v18 offset:14336
    ds_read_b64_tr_b16 a[62:63], v18 offset:14848
    ds_read_b64_tr_b16 a[64:65], v19 offset:14336
    ds_read_b64_tr_b16 a[66:67], v19 offset:14848
    ds_read_b128 a[68:71], v7 offset:36864
    v_mfma_f32_32x32x16_bf16 v[80:95], a[40:43], a[52:55], v[80:95]
    ds_read_b128 a[72:75], v7 offset:40960
    ds_read_b128 a[76:79], v7 offset:45056
    v_mfma_f32_32x32x16_bf16 v[96:111], a[40:43], a[56:59], v[96:111]
    buffer_load_dwordx4 v14, s[20:23], s61 offen offset:2048  lds
    v_mfma_f32_32x32x16_bf16 v[112:127], a[44:47], a[48:51], v[112:127]
    v_mfma_f32_32x32x16_bf16 v[128:143], a[44:47], a[52:55], v[128:143]
    s_add_u32 m0, s52, 8192
    s_lshl_b32 s61, s67, 12
    buffer_load_dwordx4 v16, s[24:27], s61 offen offset:0  lds
    v_mfma_f32_32x32x16_bf16 v[144:159], a[44:47], a[56:59], v[144:159]
    s_waitcnt lgkmcnt(0)
    v_mfma_f32_32x32x16_bf16 v[64:79], a[60:63], a[68:71], v[64:79]
    buffer_load_dwordx4 v17, s[24:27], s61 offen offset:1024  lds
    s_waitcnt vmcnt(11)
    s_barrier
    ds_read_b64_tr_b16 a[0:1], v18 offset:0
    ds_read_b64_tr_b16 a[2:3], v18 offset:512
    ds_read_b64_tr_b16 a[4:5], v19 offset:0
    ds_read_b64_tr_b16 a[6:7], v19 offset:512
    ds_read_b128 a[8:11], v8 offset:0
    v_mfma_f32_32x32x16_bf16 v[80:95], a[60:63], a[72:75], v[80:95]
    ds_read_b128 a[12:15], v8 offset:4096
    ds_read_b128 a[16:19], v8 offset:8192
    v_mfma_f32_32x32x16_bf16 v[96:111], a[60:63], a[76:79], v[96:111]
    s_add_u32 m0, s52, 10240
    s_lshl_b32 s61, s67, 12
    s_add_u32 s61, s61, 131072
    buffer_load_dwordx4 v16, s[24:27], s61 offen offset:0  lds
    v_mfma_f32_32x32x16_bf16 v[112:127], a[64:67], a[68:71], v[112:127]
    v_mfma_f32_32x32x16_bf16 v[128:143], a[64:67], a[72:75], v[128:143]
    buffer_load_dwordx4 v17, s[24:27], s61 offen offset:1024  lds
    v_mfma_f32_32x32x16_bf16 v[144:159], a[64:67], a[76:79], v[144:159]
    s_waitcnt lgkmcnt(0)
    v_mfma_f32_32x32x16_bf16 v[64:79], a[0:3], a[8:11], v[64:79]
    s_add_u32 m0, s52, 12288
    s_lshl_b32 s61, s67, 12
    s_add_u32 s61, s61, 262144
    buffer_load_dwordx4 v16, s[24:27], s61 offen offset:0  lds
    s_waitcnt vmcnt(12)
    ds_read_b64_tr_b16 a[20:21], v18 offset:2048
    ds_read_b64_tr_b16 a[22:23], v18 offset:2560
    ds_read_b64_tr_b16 a[24:25], v19 offset:2048
    ds_read_b64_tr_b16 a[26:27], v19 offset:2560
    ds_read_b128 a[28:31], v9 offset:0
    v_mfma_f32_32x32x16_bf16 v[80:95], a[0:3], a[12:15], v[80:95]
    ds_read_b128 a[32:35], v9 offset:4096
    ds_read_b128 a[36:39], v9 offset:8192
    v_mfma_f32_32x32x16_bf16 v[96:111], a[0:3], a[16:19], v[96:111]
    buffer_load_dwordx4 v17, s[24:27], s61 offen offset:1024  lds
    v_mfma_f32_32x32x16_bf16 v[112:127], a[4:7], a[8:11], v[112:127]
    v_mfma_f32_32x32x16_bf16 v[128:143], a[4:7], a[12:15], v[128:143]
    s_add_u32 m0, s52, 14336
    s_lshl_b32 s61, s67, 12
    s_add_u32 s61, s61, 393216
    buffer_load_dwordx4 v16, s[24:27], s61 offen offset:0  lds
    v_mfma_f32_32x32x16_bf16 v[144:159], a[4:7], a[16:19], v[144:159]
    s_waitcnt lgkmcnt(0)
    v_mfma_f32_32x32x16_bf16 v[64:79], a[20:23], a[28:31], v[64:79]
    buffer_load_dwordx4 v17, s[24:27], s61 offen offset:1024  lds
    s_waitcnt vmcnt(13)
    ds_read_b64_tr_b16 a[40:41], v18 offset:4096
    ds_read_b64_tr_b16 a[42:43], v18 offset:4608
    ds_read_b64_tr_b16 a[44:45], v19 offset:4096
    ds_read_b64_tr_b16 a[46:47], v19 offset:4608
    ds_read_b128 a[48:51], v10 offset:0
    v_mfma_f32_32x32x16_bf16 v[80:95], a[20:23], a[32:35], v[80:95]
    ds_read_b128 a[52:55], v10 offset:4096
    ds_read_b128 a[56:59], v10 offset:8192
    v_mfma_f32_32x32x16_bf16 v[96:111], a[20:23], a[36:39], v[96:111]
    s_add_u32 m0, s69, 73728
    s_add_u32 s61, s55, s68
    buffer_load_dwordx4 v12, s[20:23], s61 offen offset:0  lds
    v_mfma_f32_32x32x16_bf16 v[112:127], a[24:27], a[28:31], v[112:127]
    v_mfma_f32_32x32x16_bf16 v[128:143], a[24:27], a[32:35], v[128:143]
    buffer_load_dwordx4 v13, s[20:23], s61 offen offset:1024  lds
    v_mfma_f32_32x32x16_bf16 v[144:159], a[24:27], a[36:39], v[144:159]
    s_waitcnt lgkmcnt(0)
    v_mfma_f32_32x32x16_bf16 v[64:79], a[40:43], a[48:51], v[64:79]
    buffer_load_dwordx4 v14, s[20:23], s61 offen offset:2048  lds
    s_waitcnt vmcnt(14)
    ds_read_b64_tr_b16 a[60:61], v18 offset:6144
    ds_read_b64_tr_b16 a[62:63], v18 offset:6656
    ds_read_b64_tr_b16 a[64:65], v19 offset:6144
    ds_read_b64_tr_b16 a[66:67], v19 offset:6656
    ds_read_b128 a[68:71], v11 offset:0
    v_mfma_f32_32x32x16_bf16 v[80:95], a[40:43], a[52:55], v[80:95]
    ds_read_b128 a[72:75], v11 offset:4096
    ds_read_b128 a[76:79], v11 offset:8192
    v_mfma_f32_32x32x16_bf16 v[96:111], a[40:43], a[56:59], v[96:111]
    s_add_u32 m0, s52, 0
    s_lshl_b32 s61, s68, 12
    buffer_load_dwordx4 v16, s[24:27], s61 offen offset:0  lds
    v_mfma_f32_32x32x16_bf16 v[112:127], a[44:47], a[48:51], v[112:127]
    v_mfma_f32_32x32x16_bf16 v[128:143], a[44:47], a[52:55], v[128:143]
    buffer_load_dwordx4 v17, s[24:27], s61 offen offset:1024  lds
    v_mfma_f32_32x32x16_bf16 v[144:159], a[44:47], a[56:59], v[144:159]
    s_waitcnt lgkmcnt(0)
    v_mfma_f32_32x32x16_bf16 v[64:79], a[60:63], a[68:71], v[64:79]
    s_add_u32 m0, s52, 2048
    s_lshl_b32 s61, s68, 12
    s_add_u32 s61, s61, 131072
    buffer_load_dwordx4 v16, s[24:27], s61 offen offset:0  lds
    s_waitcnt vmcnt(12)
    s_barrier
    ds_read_b64_tr_b16 a[0:1], v18 offset:8192
    ds_read_b64_tr_b16 a[2:3], v18 offset:8704
    ds_read_b64_tr_b16 a[4:5], v19 offset:8192
    ds_read_b64_tr_b16 a[6:7], v19 offset:8704
    ds_read_b128 a[8:11], v8 offset:12288
    v_mfma_f32_32x32x16_bf16 v[80:95], a[60:63], a[72:75], v[80:95]
    ds_read_b128 a[12:15], v8 offset:16384
    ds_read_b128 a[16:19], v8 offset:20480
    v_mfma_f32_32x32x16_bf16 v[96:111], a[60:63], a[76:79], v[96:111]
    buffer_load_dwordx4 v17, s[24:27], s61 offen offset:1024  lds
    v_mfma_f32_32x32x16_bf16 v[112:127], a[64:67], a[68:71], v[112:127]
    v_mfma_f32_32x32x16_bf16 v[128:143], a[64:67], a[72:75], v[128:143]
    s_add_u32 m0, s52, 4096
    s_lshl_b32 s61, s68, 12
    s_add_u32 s61, s61, 262144
    buffer_load_dwordx4 v16, s[24:27], s61 offen offset:0  lds
    v_mfma_f32_32x32x16_bf16 v[144:159], a[64:67], a[76:79], v[144:159]
    s_waitcnt lgkmcnt(0)
    v_mfma_f32_32x32x16_bf16 v[64:79], a[0:3], a[8:11], v[64:79]
    buffer_load_dwordx4 v17, s[24:27], s61 offen offset:1024  lds
    s_waitcnt vmcnt(13)
    ds_read_b64_tr_b16 a[20:21], v18 offset:10240
    ds_read_b64_tr_b16 a[22:23], v18 offset:10752
    ds_read_b64_tr_b16 a[24:25], v19 offset:10240
    ds_read_b64_tr_b16 a[26:27], v19 offset:10752
    ds_read_b128 a[28:31], v9 offset:12288
    v_mfma_f32_32x32x16_bf16 v[80:95], a[0:3], a[12:15], v[80:95]
    ds_read_b128 a[32:35], v9 offset:16384
    ds_read_b128 a[36:39], v9 offset:20480
    v_mfma_f32_32x32x16_bf16 v[96:111], a[0:3], a[16:19], v[96:111]
    s_add_u32 m0, s52, 6144
    s_lshl_b32 s61, s68, 12
    s_add_u32 s61, s61, 393216
    buffer_load_dwordx4 v16, s[24:27], s61 offen offset:0  lds
    v_mfma_f32_32x32x16_bf16 v[112:127], a[4:7], a[8:11], v[112:127]
    v_mfma_f32_32x32x16_bf16 v[128:143], a[4:7], a[12:15], v[128:143]
    buffer_load_dwordx4 v17, s[24:27], s61 offen offset:1024  lds
    v_mfma_f32_32x32x16_bf16 v[144:159], a[4:7], a[16:19], v[144:159]
    s_waitcnt lgkmcnt(0)
    v_mfma_f32_32x32x16_bf16 v[64:79], a[20:23], a[28:31], v[64:79]
    s_add_u32 m0, s53, 0
    s_add_u32 s61, s3, 0
    buffer_load_dwordx4 v40, s[28:31], s61 offen offset:0 nt lds
    s_waitcnt vmcnt(14)
    ds_read_b64_tr_b16 a[40:41], v18 offset:12288
    ds_read_b64_tr_b16 a[42:43], v18 offset:12800
    ds_read_b64_tr_b16 a[44:45], v19 offset:12288
    ds_read_b64_tr_b16 a[46:47], v19 offset:12800
    ds_read_b128 a[48:51], v10 offset:12288
    v_mfma_f32_32x32x16_bf16 v[80:95], a[20:23], a[32:35], v[80:95]
    ds_read_b128 a[52:55], v10 offset:16384
    ds_read_b128 a[56:59], v10 offset:20480
    v_mfma_f32_32x32x16_bf16 v[96:111], a[20:23], a[36:39], v[96:111]
    buffer_load_dwordx4 v41, s[28:31], s61 offen offset:1024 nt lds
    v_mfma_f32_32x32x16_bf16 v[112:127], a[24:27], a[28:31], v[112:127]
    v_mfma_f32_32x32x16_bf16 v[128:143], a[24:27], a[32:35], v[128:143]
    buffer_load_dwordx4 v42, s[28:31], s61 offen offset:2048 nt lds
    v_mfma_f32_32x32x16_bf16 v[144:159], a[24:27], a[36:39], v[144:159]
    s_waitcnt lgkmcnt(0)
    v_mfma_f32_32x32x16_bf16 v[64:79], a[40:43], a[48:51], v[64:79]
    buffer_load_dwordx4 v43, s[28:31], s61 offen offset:3072 nt lds
    s_waitcnt vmcnt(15)
    ds_read_b64_tr_b16 a[60:61], v18 offset:14336
    ds_read_b64_tr_b16 a[62:63], v18 offset:14848
    ds_read_b64_tr_b16 a[64:65], v19 offset:14336
    ds_read_b64_tr_b16 a[66:67], v19 offset:14848
    ds_read_b128 a[68:71], v11 offset:12288
    v_mfma_f32_32x32x16_bf16 v[80:95], a[40:43], a[52:55], v[80:95]
    ds_read_b128 a[72:75], v11 offset:16384
    ds_read_b128 a[76:79], v11 offset:20480
    v_mfma_f32_32x32x16_bf16 v[96:111], a[40:43], a[56:59], v[96:111]
    s_add_u32 m0, s53, 4096
    s_add_u32 s61, s3, 16384
    buffer_load_dwordx4 v40, s[28:31], s61 offen offset:0 nt lds
    v_mfma_f32_32x32x16_bf16 v[112:127], a[44:47], a[48:51], v[112:127]
    v_mfma_f32_32x32x16_bf16 v[128:143], a[44:47], a[52:55], v[128:143]
    buffer_load_dwordx4 v41, s[28:31], s61 offen offset:1024 nt lds
    v_mfma_f32_32x32x16_bf16 v[144:159], a[44:47], a[56:59], v[144:159]
    s_waitcnt lgkmcnt(0)
    v_mfma_f32_32x32x16_bf16 v[64:79], a[60:63], a[68:71], v[64:79]
    buffer_load_dwordx4 v42, s[28:31], s61 offen offset:2048 nt lds
    s_waitcnt vmcnt(13)
    s_barrier
    ds_read_b64_tr_b16 a[0:1], v18 offset:0
    ds_read_b64_tr_b16 a[2:3], v18 offset:512
    ds_read_b64_tr_b16 a[4:5], v19 offset:0
    ds_read_b64_tr_b16 a[6:7], v19 offset:512
    ds_read_b128 a[8:11], v8 offset:24576
    v_mfma_f32_32x32x16_bf16 v[80:95], a[60:63], a[72:75], v[80:95]
    ds_read_b128 a[12:15], v8 offset:28672
    ds_read_b128 a[16:19], v8 offset:32768
    v_mfma_f32_32x32x16_bf16 v[96:111], a[60:63], a[76:79], v[96:111]
    buffer_load_dwordx4 v43, s[28:31], s61 offen offset:3072 nt lds
    s_waitcnt vmcnt(12)
    ds_read_b64_tr_b16 a[20:21], v18 offset:2048
    ds_read_b64_tr_b16 a[22:23], v18 offset:2560
    ds_read_b64_tr_b16 a[24:25], v19 offset:2048
    ds_read_b64_tr_b16 a[26:27], v19 offset:2560
    ds_read_b128 a[28:31], v9 offset:24576
    v_mfma_f32_32x32x16_bf16 v[112:127], a[64:67], a[68:71], v[112:127]
    ds_read_b128 a[32:35], v9 offset:28672
    ds_read_b128 a[36:39], v9 offset:32768
    v_mfma_f32_32x32x16_bf16 v[128:143], a[64:67], a[72:75], v[128:143]
    s_add_u32 m0, s52, 8192
    s_add_u32 s61, s3, 128
    buffer_load_dwordx4 v40, s[28:31], s61 offen offset:0 nt lds
    s_waitcnt vmcnt(11)
    ds_read_b64_tr_b16 a[40:41], v18 offset:4096
    ds_read_b64_tr_b16 a[42:43], v18 offset:4608
    ds_read_b64_tr_b16 a[44:45], v19 offset:4096
    ds_read_b64_tr_b16 a[46:47], v19 offset:4608
    ds_read_b128 a[48:51], v10 offset:24576
    v_mfma_f32_32x32x16_bf16 v[144:159], a[64:67], a[76:79], v[144:159]
    ds_read_b128 a[52:55], v10 offset:28672
    ds_read_b128 a[56:59], v10 offset:32768
    s_mul_i32 s56, s48, 12288
    v_add_u32 v20, s56, v3
    s_waitcnt lgkmcnt(14)
    v_mfma_f32_32x32x16_bf16 v[64:79], a[0:3], a[8:11], v[64:79]
    buffer_load_dwordx4 v41, s[28:31], s61 offen offset:1024 nt lds
    s_waitcnt vmcnt(10)
    ds_read_b64_tr_b16 a[60:61], v18 offset:6144
    ds_read_b64_tr_b16 a[62:63], v18 offset:6656
    ds_read_b64_tr_b16 a[64:65], v19 offset:6144
    ds_read_b64_tr_b16 a[66:67], v19 offset:6656
    ds_read_b128 a[68:71], v11 offset:24576
    v_mfma_f32_32x32x16_bf16 v[112:127], a[4:7], a[8:11], v[112:127]
    ds_read_b128 a[72:75], v11 offset:28672
    ds_read_b128 a[76:79], v11 offset:32768
    s_waitcnt lgkmcnt(14)
    v_mfma_f32_32x32x16_bf16 v[64:79], a[20:23], a[28:31], v[64:79]
    buffer_load_dwordx4 v42, s[28:31], s61 offen offset:2048 nt lds
    v_mfma_f32_32x32x16_bf16 v[112:127], a[24:27], a[28:31], v[112:127]
    s_waitcnt lgkmcnt(7)
    v_mfma_f32_32x32x16_bf16 v[64:79], a[40:43], a[48:51], v[64:79]
    buffer_load_dwordx4 v43, s[28:31], s61 offen offset:3072 nt lds
    v_mfma_f32_32x32x16_bf16 v[112:127], a[44:47], a[48:51], v[112:127]
    s_waitcnt lgkmcnt(0)
    s_barrier
    v_mfma_f32_32x32x16_bf16 v[64:79], a[60:63], a[68:71], v[64:79]
    s_add_u32 m0, s52, 12288
    s_add_u32 s61, s3, 16512
    buffer_load_dwordx4 v40, s[28:31], s61 offen offset:0 nt lds
    v_mfma_f32_32x32x16_bf16 v[112:127], a[64:67], a[68:71], v[112:127]
    v_mfma_f32_32x32x16_bf16 v[80:95], a[0:3], a[12:15], v[80:95]
    buffer_load_dwordx4 v41, s[28:31], s61 offen offset:1024 nt lds
    v_mfma_f32_32x32x16_bf16 v[128:143], a[4:7], a[12:15], v[128:143]
    v_cvt_pk_bf16_f32 v48, v64, v65
    v_cvt_pk_bf16_f32 v49, v66, v67
    v_cvt_pk_bf16_f32 v50, v68, v69
    v_cvt_pk_bf16_f32 v51, v70, v71
    v_mfma_f32_32x32x16_bf16 v[80:95], a[20:23], a[32:35], v[80:95]
    buffer_load_dwordx4 v42, s[28:31], s61 offen offset:2048 nt lds
    ds_write_b128 v20, v[48:51] offset:0
    v_cvt_pk_bf16_f32 v52, v72, v73
    v_cvt_pk_bf16_f32 v53, v74, v75
    v_mfma_f32_32x32x16_bf16 v[128:143], a[24:27], a[32:35], v[128:143]
    v_cvt_pk_bf16_f32 v54, v76, v77
    v_cvt_pk_bf16_f32 v55, v78, v79
    ds_write_b128 v20, v[52:55] offset:3072
    v_cvt_pk_bf16_f32 v48, v112, v113
    v_mfma_f32_32x32x16_bf16 v[80:95], a[40:43], a[52:55], v[80:95]
    buffer_load_dwordx4 v43, s[28:31], s61 offen offset:3072 nt lds
    v_cvt_pk_bf16_f32 v49, v114, v115
    v_cvt_pk_bf16_f32 v50, v116, v117
    v_cvt_pk_bf16_f32 v51, v118, v119
    v_mfma_f32_32x32x16_bf16 v[128:143], a[44:47], a[52:55], v[128:143]
    ds_write_b128 v20, v[48:51] offset:6144
    v_cvt_pk_bf16_f32 v52, v120, v121
    v_cvt_pk_bf16_f32 v53, v122, v123
    v_cvt_pk_bf16_f32 v54, v124, v125
    v_mfma_f32_32x32x16_bf16 v[80:95], a[60:63], a[72:75], v[80:95]
    s_add_u32 m0, s52, 0
    s_add_u32 s61, s3, 256
    buffer_load_dwordx4 v40, s[28:31], s61 offen offset:0 nt lds
    v_cvt_pk_bf16_f32 v55, v126, v127
    ds_write_b128 v20, v[52:55] offset:9216
    v_mfma_f32_32x32x16_bf16 v[128:143], a[64:67], a[72:75], v[128:143]
    v_mfma_f32_32x32x16_bf16 v[96:111], a[0:3], a[16:19], v[96:111]
    buffer_load_dwordx4 v41, s[28:31], s61 offen offset:1024 nt lds
    v_mfma_f32_32x32x16_bf16 v[144:159], a[4:7], a[16:19], v[144:159]
    v_cvt_pk_bf16_f32 v48, v80, v81
    v_cvt_pk_bf16_f32 v49, v82, v83
    v_cvt_pk_bf16_f32 v50, v84, v85
    v_cvt_pk_bf16_f32 v51, v86, v87
    v_mfma_f32_32x32x16_bf16 v[96:111], a[20:23], a[36:39], v[96:111]
    buffer_load_dwordx4 v42, s[28:31], s61 offen offset:2048 nt lds
    ds_write_b128 v20, v[48:51] offset:1024
    v_cvt_pk_bf16_f32 v52, v88, v89
    v_cvt_pk_bf16_f32 v53, v90, v91
    v_mfma_f32_32x32x16_bf16 v[144:159], a[24:27], a[36:39], v[144:159]
    v_cvt_pk_bf16_f32 v54, v92, v93
    v_cvt_pk_bf16_f32 v55, v94, v95
    ds_write_b128 v20, v[52:55] offset:4096
    v_cvt_pk_bf16_f32 v48, v128, v129
    v_mfma_f32_32x32x16_bf16 v[96:111], a[40:43], a[56:59], v[96:111]
    buffer_load_dwordx4 v43, s[28:31], s61 offen offset:3072 nt lds
    v_cvt_pk_bf16_f32 v49, v130, v131
    v_cvt_pk_bf16_f32 v50, v132, v133
    v_cvt_pk_bf16_f32 v51, v134, v135
    v_mfma_f32_32x32x16_bf16 v[144:159], a[44:47], a[56:59], v[144:159]
    ds_write_b128 v20, v[48:51] offset:7168
    v_cvt_pk_bf16_f32 v52, v136, v137
    v_cvt_pk_bf16_f32 v53, v138, v139
    v_cvt_pk_bf16_f32 v54, v140, v141
    v_mfma_f32_32x32x16_bf16 v[96:111], a[60:63], a[76:79], v[96:111]
    s_add_u32 m0, s52, 4096
    s_add_u32 s61, s3, 16640
    buffer_load_dwordx4 v40, s[28:31], s61 offen offset:0 nt lds
    v_cvt_pk_bf16_f32 v55, v142, v143
    ds_write_b128 v20, v[52:55] offset:10240
    v_mfma_f32_32x32x16_bf16 v[144:159], a[64:67], a[76:79], v[144:159]
    v_add_u32 v8, s53, v4
    v_add_u32 v4, s52, v4
    v_add_u32 v9, s53, v5
    v_add_u32 v5, s52, v5
    v_add_u32 v10, s53, v6
    v_add_u32 v6, s52, v6
    v_add_u32 v11, s53, v7
    v_add_u32 v7, s52, v7
    buffer_load_dwordx4 v41, s[28:31], s61 offen offset:1024 nt lds
    buffer_load_dwordx4 v42, s[28:31], s61 offen offset:2048 nt lds
    v_cvt_pk_bf16_f32 v48, v96, v97
    v_cvt_pk_bf16_f32 v49, v98, v99
    v_cvt_pk_bf16_f32 v50, v100, v101
    v_cvt_pk_bf16_f32 v51, v102, v103
    ds_write_b128 v20, v[48:51] offset:2048
    v_cvt_pk_bf16_f32 v52, v104, v105
    v_cvt_pk_bf16_f32 v53, v106, v107
    v_cvt_pk_bf16_f32 v54, v108, v109
    v_cvt_pk_bf16_f32 v55, v110, v111
    ds_write_b128 v20, v[52:55] offset:5120
    v_cvt_pk_bf16_f32 v48, v144, v145
    v_cvt_pk_bf16_f32 v49, v146, v147
    v_cvt_pk_bf16_f32 v50, v148, v149
    v_cvt_pk_bf16_f32 v51, v150, v151
    ds_write_b128 v20, v[48:51] offset:8192
    v_cvt_pk_bf16_f32 v52, v152, v153
    v_cvt_pk_bf16_f32 v53, v154, v155
    v_cvt_pk_bf16_f32 v54, v156, v157
    v_cvt_pk_bf16_f32 v55, v158, v159
    ds_write_b128 v20, v[52:55] offset:11264
    s_waitcnt vmcnt(15)
    ds_read_b128 a[0:3], v8 offset:0
    ds_read_b128 a[4:7], v8 offset:4096
    s_waitcnt lgkmcnt(2)
    s_barrier
    ds_read_b128 a[8:11], v3 offset:0
    ds_read_b128 a[12:15], v3 offset:1024
    ds_read_b128 a[16:19], v3 offset:2048
    s_waitcnt lgkmcnt(0)
    v_mfma_f32_32x32x16_bf16 v[64:79], a[0:3], a[8:11], 0
    ds_read_b128 a[20:23], v9 offset:0
    ds_read_b128 a[24:27], v9 offset:4096
    ds_read_b128 a[28:31], v3 offset:3072
    ds_read_b128 a[32:35], v3 offset:4096
    ds_read_b128 a[36:39], v3 offset:5120
    v_mfma_f32_32x32x16_bf16 v[80:95], a[0:3], a[12:15], 0
    v_lshrrev_b32 v56, 3, v1
    v_bfe_u32 v57, v1, 4, 1
    v_lshlrev_b32 v57, 2, v57
    v_and_b32 v58, 7, v1
    v_xor_b32 v58, v58, v57
    v_mfma_f32_32x32x16_bf16 v[96:111], a[0:3], a[16:19], 0
    v_lshlrev_b32 v56, 9, v56
    v_lshl_add_u32 v56, v58, 4, v56
    s_lshl_b32 s56, s48, 7
    v_add_u32 v16, s56, v56
    v_add_u32 v17, 3072, v16
    v_mfma_f32_32x32x16_bf16 v[112:127], a[4:7], a[8:11], 0
    v_lshrrev_b32 v56, 5, v1
    v_bfe_u32 v57, v1, 2, 2
    v_and_b32 v58, 3, v1
    v_bfe_u32 v59, v1, 4, 1
    v_and_b32 v60, 1, v58
    v_mfma_f32_32x32x16_bf16 v[128:143], a[4:7], a[12:15], 0
    buffer_load_dwordx4 v43, s[28:31], s61 offen offset:3072 nt lds
    v_lshrrev_b32 v58, 1, v58
    v_lshl_add_u32 v59, v59, 1, v58
    v_lshrrev_b32 v61, 1, v57
    v_lshlrev_b32 v61, 2, v61
    v_mfma_f32_32x32x16_bf16 v[144:159], a[4:7], a[16:19], 0
    v_xor_b32 v59, v59, v61
    v_lshl_add_u32 v56, v56, 2, v57
    v_lshlrev_b32 v56, 7, v56
    v_lshl_add_u32 v56, v59, 4, v56
    v_lshl_add_u32 v56, v60, 3, v56
    s_waitcnt lgkmcnt(0)
    v_mfma_f32_32x32x16_bf16 v[64:79], a[20:23], a[28:31], v[64:79]
    ds_read_b128 a[40:43], v10 offset:0
    ds_read_b128 a[44:47], v10 offset:4096
    ds_read_b128 a[48:51], v3 offset:6144
    ds_read_b128 a[52:55], v3 offset:7168
    ds_read_b128 a[56:59], v3 offset:8192
    v_mfma_f32_32x32x16_bf16 v[80:95], a[20:23], a[32:35], v[80:95]
    v_add_u32 v18, s52, v56
    v_xor_b32 v19, 64, v18
    v_add_u32 v20, s53, v56
    v_xor_b32 v21, 64, v20
    v_and_b32 v23, 31, v1
    v_mfma_f32_32x32x16_bf16 v[96:111], a[20:23], a[36:39], v[96:111]
    v_lshlrev_b32 v23, 4, v23
    v_add_u32 v23, 86016, v23
    s_lshl_b32 s56, s48, 2
    v_add_u32 v24, s56, v23
    s_mul_i32 s56, s48, 6144
    v_mfma_f32_32x32x16_bf16 v[112:127], a[24:27], a[28:31], v[112:127]
    v_add_u32 v22, s56, v3
    v_mfma_f32_32x32x16_bf16 v[128:143], a[24:27], a[32:35], v[128:143]
    v_mfma_f32_32x32x16_bf16 v[144:159], a[24:27], a[36:39], v[144:159]
    s_waitcnt lgkmcnt(0)
    v_mfma_f32_32x32x16_bf16 v[64:79], a[40:43], a[48:51], v[64:79]
    s_lshl_b32 s56, s49, 4
    v_mov_b32 v60, s56
    v_mov_b32 v61, 1
    s_and_b32 s57, s100, 1
    s_mov_b32 exec_lo, s57
    s_mov_b32 exec_hi, 0
    global_store_dword v60, v61, s[16:17] sc1
    s_mov_b64 exec, -1
    ds_read_b128 a[60:63], v11 offset:0
    ds_read_b128 a[64:67], v11 offset:4096
    ds_read_b128 a[68:71], v3 offset:9216
    ds_read_b128 a[72:75], v3 offset:10240
    ds_read_b128 a[76:79], v3 offset:11264
    v_mfma_f32_32x32x16_bf16 v[80:95], a[40:43], a[52:55], v[80:95]
    v_mfma_f32_32x32x16_bf16 v[96:111], a[40:43], a[56:59], v[96:111]
    v_mfma_f32_32x32x16_bf16 v[112:127], a[44:47], a[48:51], v[112:127]
    v_mfma_f32_32x32x16_bf16 v[128:143], a[44:47], a[52:55], v[128:143]
    v_mfma_f32_32x32x16_bf16 v[144:159], a[44:47], a[56:59], v[144:159]
    s_waitcnt lgkmcnt(0)
    v_mfma_f32_32x32x16_bf16 v[64:79], a[60:63], a[68:71], v[64:79]
    s_add_u32 m0, s53, 0
    s_add_u32 s61, s3, 384
    buffer_load_dwordx4 v40, s[28:31], s61 offen offset:0 nt lds
    s_waitcnt vmcnt(10)
    ds_read_b128 a[0:3], v4 offset:8192
    ds_read_b128 a[4:7], v4 offset:12288
    ds_read_b128 a[8:11], v3 offset:12288
    ds_read_b128 a[12:15], v3 offset:13312
    ds_read_b128 a[16:19], v3 offset:14336
    v_mfma_f32_32x32x16_bf16 v[80:95], a[60:63], a[72:75], v[80:95]
    v_mfma_f32_32x32x16_bf16 v[96:111], a[60:63], a[76:79], v[96:111]
    v_mfma_f32_32x32x16_bf16 v[112:127], a[64:67], a[68:71], v[112:127]
    buffer_load_dwordx4 v41, s[28:31], s61 offen offset:1024 nt lds
    v_mfma_f32_32x32x16_bf16 v[128:143], a[64:67], a[72:75], v[128:143]
    v_mfma_f32_32x32x16_bf16 v[144:159], a[64:67], a[76:79], v[144:159]
    buffer_load_dwordx4 v42, s[28:31], s61 offen offset:2048 nt lds
    s_waitcnt lgkmcnt(0)
    v_mfma_f32_32x32x16_bf16 v[64:79], a[0:3], a[8:11], v[64:79]
    ds_read_b128 a[20:23], v5 offset:8192
    ds_read_b128 a[24:27], v5 offset:12288
    ds_read_b128 a[28:31], v3 offset:15360
    ds_read_b128 a[32:35], v3 offset:16384
    ds_read_b128 a[36:39], v3 offset:17408
    v_mfma_f32_32x32x16_bf16 v[80:95], a[0:3], a[12:15], v[80:95]
    v_mfma_f32_32x32x16_bf16 v[96:111], a[0:3], a[16:19], v[96:111]
    buffer_load_dwordx4 v43, s[28:31], s61 offen offset:3072 nt lds
    v_mfma_f32_32x32x16_bf16 v[112:127], a[4:7], a[8:11], v[112:127]
    v_mfma_f32_32x32x16_bf16 v[128:143], a[4:7], a[12:15], v[128:143]
    s_add_u32 m0, s53, 4096
    s_add_u32 s61, s3, 16768
    buffer_load_dwordx4 v40, s[28:31], s61 offen offset:0 nt lds
    v_mfma_f32_32x32x16_bf16 v[144:159], a[4:7], a[16:19], v[144:159]
    s_waitcnt lgkmcnt(0)
    v_mfma_f32_32x32x16_bf16 v[64:79], a[20:23], a[28:31], v[64:79]
    ds_read_b128 a[40:43], v6 offset:8192
    ds_read_b128 a[44:47], v6 offset:12288
    ds_read_b128 a[48:51], v3 offset:18432
    ds_read_b128 a[52:55], v3 offset:19456
    ds_read_b128 a[56:59], v3 offset:20480
    v_mfma_f32_32x32x16_bf16 v[80:95], a[20:23], a[32:35], v[80:95]
    buffer_load_dwordx4 v41, s[28:31], s61 offen offset:1024 nt lds
    v_mfma_f32_32x32x16_bf16 v[96:111], a[20:23], a[36:39], v[96:111]
    v_mfma_f32_32x32x16_bf16 v[112:127], a[24:27], a[28:31], v[112:127]
    buffer_load_dwordx4 v42, s[28:31], s61 offen offset:2048 nt lds
    v_mfma_f32_32x32x16_bf16 v[128:143], a[24:27], a[32:35], v[128:143]
    v_mfma_f32_32x32x16_bf16 v[144:159], a[24:27], a[36:39], v[144:159]
    s_waitcnt lgkmcnt(0)
    v_mfma_f32_32x32x16_bf16 v[64:79], a[40:43], a[48:51], v[64:79]
    buffer_load_dwordx4 v43, s[28:31], s61 offen offset:3072 nt lds
    ds_read_b128 a[60:63], v7 offset:8192
    ds_read_b128 a[64:67], v7 offset:12288
    ds_read_b128 a[68:71], v3 offset:21504
    ds_read_b128 a[72:75], v3 offset:22528
    ds_read_b128 a[76:79], v3 offset:23552
    v_mfma_f32_32x32x16_bf16 v[80:95], a[40:43], a[52:55], v[80:95]
    v_mfma_f32_32x32x16_bf16 v[96:111], a[40:43], a[56:59], v[96:111]
    v_mfma_f32_32x32x16_bf16 v[112:127], a[44:47], a[48:51], v[112:127]
    v_mfma_f32_32x32x16_bf16 v[128:143], a[44:47], a[52:55], v[128:143]
    v_mfma_f32_32x32x16_bf16 v[144:159], a[44:47], a[56:59], v[144:159]
    s_waitcnt lgkmcnt(0)
    v_mfma_f32_32x32x16_bf16 v[64:79], a[60:63], a[68:71], v[64:79]
    s_add_u32 m0, s52, 8192
    s_add_u32 s61, s3, 32768
    buffer_load_dwordx4 v40, s[28:31], s61 offen offset:0 nt lds
    s_waitcnt vmcnt(10)
    ds_read_b128 a[0:3], v4 offset:0
    ds_read_b128 a[4:7], v4 offset:4096
    ds_read_b128 a[8:11], v3 offset:24576
    ds_read_b128 a[12:15], v3 offset:25600
    ds_read_b128 a[16:19], v3 offset:26624
    v_mfma_f32_32x32x16_bf16 v[80:95], a[60:63], a[72:75], v[80:95]
    v_mfma_f32_32x32x16_bf16 v[96:111], a[60:63], a[76:79], v[96:111]
    v_mfma_f32_32x32x16_bf16 v[112:127], a[64:67], a[68:71], v[112:127]
    buffer_load_dwordx4 v41, s[28:31], s61 offen offset:1024 nt lds
    v_mfma_f32_32x32x16_bf16 v[128:143], a[64:67], a[72:75], v[128:143]
    v_mfma_f32_32x32x16_bf16 v[144:159], a[64:67], a[76:79], v[144:159]
    buffer_load_dwordx4 v42, s[28:31], s61 offen offset:2048 nt lds
    s_waitcnt lgkmcnt(0)
    v_mfma_f32_32x32x16_bf16 v[64:79], a[0:3], a[8:11], v[64:79]
    ds_read_b128 a[20:23], v5 offset:0
    ds_read_b128 a[24:27], v5 offset:4096
    ds_read_b128 a[28:31], v3 offset:27648
    ds_read_b128 a[32:35], v3 offset:28672
    ds_read_b128 a[36:39], v3 offset:29696
    v_mfma_f32_32x32x16_bf16 v[80:95], a[0:3], a[12:15], v[80:95]
    v_mfma_f32_32x32x16_bf16 v[96:111], a[0:3], a[16:19], v[96:111]
    buffer_load_dwordx4 v43, s[28:31], s61 offen offset:3072 nt lds
    v_mfma_f32_32x32x16_bf16 v[112:127], a[4:7], a[8:11], v[112:127]
    v_mfma_f32_32x32x16_bf16 v[128:143], a[4:7], a[12:15], v[128:143]
    s_add_u32 m0, s52, 12288
    s_add_u32 s61, s3, 49152
    buffer_load_dwordx4 v40, s[28:31], s61 offen offset:0 nt lds
    v_mfma_f32_32x32x16_bf16 v[144:159], a[4:7], a[16:19], v[144:159]
    s_waitcnt lgkmcnt(0)
    v_mfma_f32_32x32x16_bf16 v[64:79], a[20:23], a[28:31], v[64:79]
    ds_read_b128 a[40:43], v6 offset:0
    ds_read_b128 a[44:47], v6 offset:4096
    ds_read_b128 a[48:51], v3 offset:30720
    ds_read_b128 a[52:55], v3 offset:31744
    ds_read_b128 a[56:59], v3 offset:32768
    v_mfma_f32_32x32x16_bf16 v[80:95], a[20:23], a[32:35], v[80:95]
    buffer_load_dwordx4 v41, s[28:31], s61 offen offset:1024 nt lds
    v_mfma_f32_32x32x16_bf16 v[96:111], a[20:23], a[36:39], v[96:111]
    v_mfma_f32_32x32x16_bf16 v[112:127], a[24:27], a[28:31], v[112:127]
    buffer_load_dwordx4 v42, s[28:31], s61 offen offset:2048 nt lds
    v_mfma_f32_32x32x16_bf16 v[128:143], a[24:27], a[32:35], v[128:143]
    v_mfma_f32_32x32x16_bf16 v[144:159], a[24:27], a[36:39], v[144:159]
    s_waitcnt lgkmcnt(0)
    v_mfma_f32_32x32x16_bf16 v[64:79], a[40:43], a[48:51], v[64:79]
    buffer_load_dwordx4 v43, s[28:31], s61 offen offset:3072 nt lds
    ds_read_b128 a[60:63], v7 offset:0
    ds_read_b128 a[64:67], v7 offset:4096
    ds_read_b128 a[68:71], v3 offset:33792
    ds_read_b128 a[72:75], v3 offset:34816
    ds_read_b128 a[76:79], v3 offset:35840
    v_mfma_f32_32x32x16_bf16 v[80:95], a[40:43], a[52:55], v[80:95]
    v_mfma_f32_32x32x16_bf16 v[96:111], a[40:43], a[56:59], v[96:111]
    v_mfma_f32_32x32x16_bf16 v[112:127], a[44:47], a[48:51], v[112:127]
    v_mfma_f32_32x32x16_bf16 v[128:143], a[44:47], a[52:55], v[128:143]
    v_mfma_f32_32x32x16_bf16 v[144:159], a[44:47], a[56:59], v[144:159]
    s_waitcnt lgkmcnt(0)
    v_mfma_f32_32x32x16_bf16 v[64:79], a[60:63], a[68:71], v[64:79]
    s_add_u32 m0, s52, 0
    s_add_u32 s61, s3, 32896
    buffer_load_dwordx4 v40, s[28:31], s61 offen offset:0 nt lds
    s_waitcnt vmcnt(9)
    ds_read_b128 a[0:3], v8 offset:0
    ds_read_b128 a[4:7], v8 offset:4096
    ds_read_b128 a[8:11], v3 offset:36864
    ds_read_b128 a[12:15], v3 offset:37888
    ds_read_b128 a[16:19], v3 offset:38912
    v_mfma_f32_32x32x16_bf16 v[80:95], a[60:63], a[72:75], v[80:95]
    v_mfma_f32_32x32x16_bf16 v[96:111], a[60:63], a[76:79], v[96:111]
    v_mfma_f32_32x32x16_bf16 v[112:127], a[64:67], a[68:71], v[112:127]
    buffer_load_dwordx4 v41, s[28:31], s61 offen offset:1024 nt lds
    v_mfma_f32_32x32x16_bf16 v[128:143], a[64:67], a[72:75], v[128:143]
    v_mfma_f32_32x32x16_bf16 v[144:159], a[64:67], a[76:79], v[144:159]
    buffer_load_dwordx4 v42, s[28:31], s61 offen offset:2048 nt lds
    s_waitcnt lgkmcnt(0)
    v_mfma_f32_32x32x16_bf16 v[64:79], a[0:3], a[8:11], v[64:79]
    ds_read_b128 a[20:23], v9 offset:0
    ds_read_b128 a[24:27], v9 offset:4096
    ds_read_b128 a[28:31], v3 offset:39936
    ds_read_b128 a[32:35], v3 offset:40960
    ds_read_b128 a[36:39], v3 offset:41984
    v_mfma_f32_32x32x16_bf16 v[80:95], a[0:3], a[12:15], v[80:95]
    v_mfma_f32_32x32x16_bf16 v[96:111], a[0:3], a[16:19], v[96:111]
    buffer_load_dwordx4 v43, s[28:31], s61 offen offset:3072 nt lds
    v_mfma_f32_32x32x16_bf16 v[112:127], a[4:7], a[8:11], v[112:127]
    v_mfma_f32_32x32x16_bf16 v[128:143], a[4:7], a[12:15], v[128:143]
    s_add_u32 m0, s52, 4096
    s_add_u32 s61, s3, 49280
    buffer_load_dwordx4 v40, s[28:31], s61 offen offset:0 nt lds
    v_mfma_f32_32x32x16_bf16 v[144:159], a[4:7], a[16:19], v[144:159]
    s_waitcnt lgkmcnt(0)
    v_mfma_f32_32x32x16_bf16 v[64:79], a[20:23], a[28:31], v[64:79]
    ds_read_b128 a[40:43], v10 offset:0
    ds_read_b128 a[44:47], v10 offset:4096
    ds_read_b128 a[48:51], v3 offset:43008
    ds_read_b128 a[52:55], v3 offset:44032
    ds_read_b128 a[56:59], v3 offset:45056
    v_mfma_f32_32x32x16_bf16 v[80:95], a[20:23], a[32:35], v[80:95]
    buffer_load_dwordx4 v41, s[28:31], s61 offen offset:1024 nt lds
    v_mfma_f32_32x32x16_bf16 v[96:111], a[20:23], a[36:39], v[96:111]
    v_mfma_f32_32x32x16_bf16 v[112:127], a[24:27], a[28:31], v[112:127]
    buffer_load_dwordx4 v42, s[28:31], s61 offen offset:2048 nt lds
    v_mfma_f32_32x32x16_bf16 v[128:143], a[24:27], a[32:35], v[128:143]
    v_mfma_f32_32x32x16_bf16 v[144:159], a[24:27], a[36:39], v[144:159]
    s_waitcnt lgkmcnt(0)
    v_mfma_f32_32x32x16_bf16 v[64:79], a[40:43], a[48:51], v[64:79]
    buffer_load_dwordx4 v43, s[28:31], s61 offen offset:3072 nt lds
    ds_read_b128 a[60:63], v11 offset:0
    ds_read_b128 a[64:67], v11 offset:4096
    ds_read_b128 a[68:71], v3 offset:46080
    ds_read_b128 a[72:75], v3 offset:47104
    ds_read_b128 a[76:79], v3 offset:48128
    v_mfma_f32_32x32x16_bf16 v[80:95], a[40:43], a[52:55], v[80:95]
    v_mfma_f32_32x32x16_bf16 v[96:111], a[40:43], a[56:59], v[96:111]
    v_mfma_f32_32x32x16_bf16 v[112:127], a[44:47], a[48:51], v[112:127]
    v_mfma_f32_32x32x16_bf16 v[128:143], a[44:47], a[52:55], v[128:143]
    v_mfma_f32_32x32x16_bf16 v[144:159], a[44:47], a[56:59], v[144:159]
    s_waitcnt lgkmcnt(0)
    v_mfma_f32_32x32x16_bf16 v[64:79], a[60:63], a[68:71], v[64:79]
    s_add_u32 m0, s53, 0
    s_add_u32 s61, s3, 33024
    buffer_load_dwordx4 v40, s[28:31], s61 offen offset:0 nt lds
    s_waitcnt vmcnt(9)
    ds_read_b128 a[0:3], v4 offset:8192
    ds_read_b128 a[4:7], v4 offset:12288
    ds_read_b128 a[8:11], v3 offset:0
    ds_read_b128 a[12:15], v3 offset:1024
    ds_read_b128 a[16:19], v3 offset:2048
    v_mfma_f32_32x32x16_bf16 v[80:95], a[60:63], a[72:75], v[80:95]
    v_mfma_f32_32x32x16_bf16 v[96:111], a[60:63], a[76:79], v[96:111]
    v_mfma_f32_32x32x16_bf16 v[112:127], a[64:67], a[68:71], v[112:127]
    buffer_load_dwordx4 v41, s[28:31], s61 offen offset:1024 nt lds
    v_mfma_f32_32x32x16_bf16 v[128:143], a[64:67], a[72:75], v[128:143]
    v_mfma_f32_32x32x16_bf16 v[144:159], a[64:67], a[76:79], v[144:159]
    buffer_load_dwordx4 v42, s[28:31], s61 offen offset:2048 nt lds
    s_waitcnt lgkmcnt(0)
    v_mfma_f32_32x32x16_bf16 v[160:175], a[0:3], a[8:11], 0
    ds_read_b128 a[20:23], v5 offset:8192
    ds_read_b128 a[24:27], v5 offset:12288
    ds_read_b128 a[28:31], v3 offset:3072
    ds_read_b128 a[32:35], v3 offset:4096
    ds_read_b128 a[36:39], v3 offset:5120
    v_mfma_f32_32x32x16_bf16 v[176:191], a[0:3], a[12:15], 0
    v_mfma_f32_32x32x16_bf16 v[192:207], a[0:3], a[16:19], 0
    buffer_load_dwordx4 v43, s[28:31], s61 offen offset:3072 nt lds
    v_max_f32 v25, v64, v65
    v_max3_f32 v25, v25, v66, v67
    v_max3_f32 v25, v25, v68, v69
    v_max3_f32 v25, v25, v70, v71
    v_mfma_f32_32x32x16_bf16 v[208:223], a[4:7], a[8:11], 0
    v_max3_f32 v25, v25, v72, v73
    v_max3_f32 v25, v25, v74, v75
    v_max3_f32 v25, v25, v76, v77
    v_max3_f32 v25, v25, v78, v79
    v_max3_f32 v25, v25, v112, v113
    v_mfma_f32_32x32x16_bf16 v[224:239], a[4:7], a[12:15], 0
    s_add_u32 m0, s53, 4096
    s_add_u32 s61, s3, 49408
    buffer_load_dwordx4 v40, s[28:31], s61 offen offset:0 nt lds
    v_max3_f32 v25, v25, v114, v115
    v_max3_f32 v25, v25, v116, v117
    v_mfma_f32_32x32x16_bf16 v[240:255], a[4:7], a[16:19], 0
    v_max3_f32 v25, v25, v118, v119
    v_max3_f32 v25, v25, v120, v121
    v_max3_f32 v25, v25, v122, v123
    v_max3_f32 v25, v25, v124, v125
    v_max3_f32 v25, v25, v126, v127
    s_waitcnt lgkmcnt(0)
    v_mfma_f32_32x32x16_bf16 v[160:175], a[20:23], a[28:31], v[160:175]
    ds_read_b128 a[40:43], v6 offset:8192
    ds_read_b128 a[44:47], v6 offset:12288
    ds_read_b128 a[48:51], v3 offset:6144
    ds_read_b128 a[52:55], v3 offset:7168
    ds_read_b128 a[56:59], v3 offset:8192
    v_max_f32 v26, v80, v81
    v_max3_f32 v26, v26, v82, v83
    v_max3_f32 v26, v26, v84, v85
    v_mfma_f32_32x32x16_bf16 v[176:191], a[20:23], a[32:35], v[176:191]
    buffer_load_dwordx4 v41, s[28:31], s61 offen offset:1024 nt lds
    v_max3_f32 v26, v26, v86, v87
    v_max3_f32 v26, v26, v88, v89
    v_max3_f32 v26, v26, v90, v91
    v_max3_f32 v26, v26, v92, v93
    v_max3_f32 v26, v26, v94, v95
    v_mfma_f32_32x32x16_bf16 v[192:207], a[20:23], a[36:39], v[192:207]
    v_max3_f32 v26, v26, v128, v129
    v_max3_f32 v26, v26, v130, v131
    v_max3_f32 v26, v26, v132, v133
    v_max3_f32 v26, v26, v134, v135
    v_max3_f32 v26, v26, v136, v137
    v_mfma_f32_32x32x16_bf16 v[208:223], a[24:27], a[28:31], v[208:223]
    buffer_load_dwordx4 v42, s[28:31], s61 offen offset:2048 nt lds
    v_max3_f32 v26, v26, v138, v139
    v_max3_f32 v26, v26, v140, v141
    v_max3_f32 v26, v26, v142, v143
    v_max_f32 v27, v96, v97
    v_max3_f32 v27, v27, v98, v99
    v_mfma_f32_32x32x16_bf16 v[224:239], a[24:27], a[32:35], v[224:239]
    v_max3_f32 v27, v27, v100, v101
    v_max3_f32 v27, v27, v102, v103
    v_max3_f32 v27, v27, v104, v105
    v_max3_f32 v27, v27, v106, v107
    v_max3_f32 v27, v27, v108, v109
    v_mfma_f32_32x32x16_bf16 v[240:255], a[24:27], a[36:39], v[240:255]
    v_max3_f32 v27, v27, v110, v111
    v_max3_f32 v27, v27, v144, v145
    v_max3_f32 v27, v27, v146, v147
    v_max3_f32 v27, v27, v148, v149
    v_max3_f32 v27, v27, v150, v151
    s_waitcnt lgkmcnt(0)
    v_mfma_f32_32x32x16_bf16 v[160:175], a[40:43], a[48:51], v[160:175]
    buffer_load_dwordx4 v43, s[28:31], s61 offen offset:3072 nt lds
    ds_read_b128 a[60:63], v7 offset:8192
    ds_read_b128 a[64:67], v7 offset:12288
    ds_read_b128 a[68:71], v3 offset:9216
    ds_read_b128 a[72:75], v3 offset:10240
    ds_read_b128 a[76:79], v3 offset:11264
    v_max3_f32 v27, v27, v152, v153
    v_max3_f32 v27, v27, v154, v155
    v_max3_f32 v27, v27, v156, v157
    v_max3_f32 v27, v27, v158, v159
    v_mfma_f32_32x32x16_bf16 v[176:191], a[40:43], a[52:55], v[176:191]
    v_mfma_f32_32x32x16_bf16 v[192:207], a[40:43], a[56:59], v[192:207]
    v_mov_b32 v56, v25
    v_mov_b32 v57, v26
    v_mov_b32 v58, v27
    s_nop 1
    v_permlane32_swap_b32 v25, v56
    v_permlane32_swap_b32 v26, v57
    v_permlane32_swap_b32 v27, v58
    s_nop 0
    v_max_f32 v25, v25, v56
    v_max_f32 v26, v26, v57
    v_max_f32 v27, v27, v58
    v_mfma_f32_32x32x16_bf16 v[208:223], a[44:47], a[48:51], v[208:223]
    v_mov_b32 v28, v25
    v_mul_f32 v25, s60, v25
    v_sub_f32 v25, 0, v25
    v_mov_b32 v34, 0
    v_mov_b32 v35, 0
    v_mfma_f32_32x32x16_bf16 v[224:239], a[44:47], a[52:55], v[224:239]
    v_mov_b32 v29, v26
    v_mul_f32 v26, s60, v26
    v_sub_f32 v26, 0, v26
    v_mov_b32 v36, 0
    v_mov_b32 v37, 0
    v_mfma_f32_32x32x16_bf16 v[240:255], a[44:47], a[56:59], v[240:255]
    v_mov_b32 v30, v27
    v_mul_f32 v27, s60, v27
    v_sub_f32 v27, 0, v27
    v_mov_b32 v38, 0
    v_mov_b32 v39, 0
    s_waitcnt lgkmcnt(0)
    v_mfma_f32_32x32x16_bf16 v[160:175], a[60:63], a[68:71], v[160:175]
    s_add_u32 m0, s52, 8192
    s_add_u32 s61, s3, 33152
    buffer_load_dwordx4 v40, s[28:31], s61 offen offset:0 nt lds
    s_waitcnt vmcnt(9)
    ds_read_b128 a[0:3], v4 offset:0
    ds_read_b128 a[4:7], v4 offset:4096
    ds_read_b128 a[8:11], v3 offset:12288
    ds_read_b128 a[12:15], v3 offset:13312
    ds_read_b128 a[16:19], v3 offset:14336
    v_fma_f32 v64, v64, s60, v25
    v_fma_f32 v65, v65, s60, v25
    v_exp_f32 v64, v64
    v_mfma_f32_32x32x16_bf16 v[176:191], a[60:63], a[72:75], v[176:191]
    v_exp_f32 v65, v65
    v_fma_f32 v66, v66, s60, v25
    v_fma_f32 v67, v67, s60, v25
    v_exp_f32 v66, v66
    v_mfma_f32_32x32x16_bf16 v[192:207], a[60:63], a[76:79], v[192:207]
    v_exp_f32 v67, v67
    v_add_f32 v34, v34, v64
    v_add_f32 v35, v35, v65
    v_fma_f32 v68, v68, s60, v25
    v_mfma_f32_32x32x16_bf16 v[208:223], a[64:67], a[68:71], v[208:223]
    buffer_load_dwordx4 v41, s[28:31], s61 offen offset:1024 nt lds
    v_fma_f32 v69, v69, s60, v25
    v_exp_f32 v68, v68
    v_exp_f32 v69, v69
    v_mfma_f32_32x32x16_bf16 v[224:239], a[64:67], a[72:75], v[224:239]
    v_add_f32 v34, v34, v66
    v_add_f32 v35, v35, v67
    v_fma_f32 v70, v70, s60, v25
    v_fma_f32 v71, v71, s60, v25
    v_mfma_f32_32x32x16_bf16 v[240:255], a[64:67], a[76:79], v[240:255]
    buffer_load_dwordx4 v42, s[28:31], s61 offen offset:2048 nt lds
    v_exp_f32 v70, v70
    v_exp_f32 v71, v71
    v_add_f32 v34, v34, v68
    v_add_f32 v35, v35, v69
    s_waitcnt lgkmcnt(0)
    v_mfma_f32_32x32x16_bf16 v[160:175], a[0:3], a[8:11], v[160:175]
    ds_read_b128 a[20:23], v5 offset:0
    ds_read_b128 a[24:27], v5 offset:4096
    ds_read_b128 a[28:31], v3 offset:15360
    ds_read_b128 a[32:35], v3 offset:16384
    ds_read_b128 a[36:39], v3 offset:17408
    v_fma_f32 v72, v72, s60, v25
    v_fma_f32 v73, v73, s60, v25
    v_exp_f32 v72, v72
    v_mfma_f32_32x32x16_bf16 v[176:191], a[0:3], a[12:15], v[176:191]
    v_exp_f32 v73, v73
    v_add_f32 v34, v34, v70
    v_add_f32 v35, v35, v71
    v_fma_f32 v74, v74, s60, v25
    v_fma_f32 v75, v75, s60, v25
    v_mfma_f32_32x32x16_bf16 v[192:207], a[0:3], a[16:19], v[192:207]
    buffer_load_dwordx4 v43, s[28:31], s61 offen offset:3072 nt lds
    v_exp_f32 v74, v74
    v_exp_f32 v75, v75
    v_add_f32 v34, v34, v72
    v_mfma_f32_32x32x16_bf16 v[208:223], a[4:7], a[8:11], v[208:223]
    v_add_f32 v35, v35, v73
    v_fma_f32 v76, v76, s60, v25
    v_fma_f32 v77, v77, s60, v25
    v_exp_f32 v76, v76
    v_mfma_f32_32x32x16_bf16 v[224:239], a[4:7], a[12:15], v[224:239]
    s_add_u32 m0, s52, 12288
    s_add_u32 s61, s3, 49536
    buffer_load_dwordx4 v40, s[28:31], s61 offen offset:0 nt lds
    v_exp_f32 v77, v77
    v_add_f32 v34, v34, v74
    v_add_f32 v35, v35, v75
    v_fma_f32 v78, v78, s60, v25
    v_mfma_f32_32x32x16_bf16 v[240:255], a[4:7], a[16:19], v[240:255]
    v_fma_f32 v79, v79, s60, v25
    v_exp_f32 v78, v78
    v_exp_f32 v79, v79
    s_waitcnt lgkmcnt(0)
    v_mfma_f32_32x32x16_bf16 v[160:175], a[20:23], a[28:31], v[160:175]
    ds_read_b128 a[40:43], v6 offset:0
    ds_read_b128 a[44:47], v6 offset:4096
    ds_read_b128 a[48:51], v3 offset:18432
    ds_read_b128 a[52:55], v3 offset:19456
    ds_read_b128 a[56:59], v3 offset:20480
    v_add_f32 v34, v34, v76
    v_add_f32 v35, v35, v77
    v_fma_f32 v80, v80, s60, v26
    v_fma_f32 v81, v81, s60, v26
    v_mfma_f32_32x32x16_bf16 v[176:191], a[20:23], a[32:35], v[176:191]
    buffer_load_dwordx4 v41, s[28:31], s61 offen offset:1024 nt lds
    v_exp_f32 v80, v80
    v_exp_f32 v81, v81
    v_add_f32 v34, v34, v78
    v_add_f32 v35, v35, v79
    v_mfma_f32_32x32x16_bf16 v[192:207], a[20:23], a[36:39], v[192:207]
    v_fma_f32 v82, v82, s60, v26
    v_fma_f32 v83, v83, s60, v26
    v_exp_f32 v82, v82
    v_mfma_f32_32x32x16_bf16 v[208:223], a[24:27], a[28:31], v[208:223]
    buffer_load_dwordx4 v42, s[28:31], s61 offen offset:2048 nt lds
    v_exp_f32 v83, v83
    v_add_f32 v36, v36, v80
    v_add_f32 v37, v37, v81
    v_fma_f32 v84, v84, s60, v26
    v_fma_f32 v85, v85, s60, v26
    v_mfma_f32_32x32x16_bf16 v[224:239], a[24:27], a[32:35], v[224:239]
    v_exp_f32 v84, v84
    v_exp_f32 v85, v85
    v_add_f32 v36, v36, v82
    v_mfma_f32_32x32x16_bf16 v[240:255], a[24:27], a[36:39], v[240:255]
    v_add_f32 v37, v37, v83
    v_fma_f32 v86, v86, s60, v26
    v_fma_f32 v87, v87, s60, v26
    v_exp_f32 v86, v86
    s_waitcnt lgkmcnt(0)
    v_mfma_f32_32x32x16_bf16 v[160:175], a[40:43], a[48:51], v[160:175]
    buffer_load_dwordx4 v43, s[28:31], s61 offen offset:3072 nt lds
    ds_read_b128 a[60:63], v7 offset:0
    ds_read_b128 a[64:67], v7 offset:4096
    ds_read_b128 a[68:71], v3 offset:21504
    ds_read_b128 a[72:75], v3 offset:22528
    ds_read_b128 a[76:79], v3 offset:23552
    v_exp_f32 v87, v87
    v_add_f32 v36, v36, v84
    v_add_f32 v37, v37, v85
    v_fma_f32 v88, v88, s60, v26
    v_mfma_f32_32x32x16_bf16 v[176:191], a[40:43], a[52:55], v[176:191]
    v_fma_f32 v89, v89, s60, v26
    v_exp_f32 v88, v88
    v_exp_f32 v89, v89
    v_mfma_f32_32x32x16_bf16 v[192:207], a[40:43], a[56:59], v[192:207]
    v_add_f32 v36, v36, v86
    v_add_f32 v37, v37, v87
    v_fma_f32 v90, v90, s60, v26
    v_fma_f32 v91, v91, s60, v26
    v_mfma_f32_32x32x16_bf16 v[208:223], a[44:47], a[48:51], v[208:223]
    v_exp_f32 v90, v90
    v_exp_f32 v91, v91
    v_add_f32 v36, v36, v88
    v_add_f32 v37, v37, v89
    v_mfma_f32_32x32x16_bf16 v[224:239], a[44:47], a[52:55], v[224:239]
    v_fma_f32 v92, v92, s60, v26
    v_fma_f32 v93, v93, s60, v26
    v_exp_f32 v92, v92
    v_mfma_f32_32x32x16_bf16 v[240:255], a[44:47], a[56:59], v[240:255]
    v_exp_f32 v93, v93
    v_add_f32 v36, v36, v90
    v_add_f32 v37, v37, v91
    v_fma_f32 v94, v94, s60, v26
    v_fma_f32 v95, v95, s60, v26
    s_waitcnt lgkmcnt(0)
    v_mfma_f32_32x32x16_bf16 v[160:175], a[60:63], a[68:71], v[160:175]
    s_add_u32 m0, s52, 0
    s_mov_b32 s61, 0
    buffer_load_dwordx4 v16, s[32:35], s61 offen offset:0 nt lds
    s_waitcnt vmcnt(9)
    ds_read_b128 a[0:3], v8 offset:0
    ds_read_b128 a[4:7], v8 offset:4096
    ds_read_b128 a[8:11], v3 offset:24576
    ds_read_b128 a[12:15], v3 offset:25600
    ds_read_b128 a[16:19], v3 offset:26624
    v_exp_f32 v94, v94
    v_exp_f32 v95, v95
    v_add_f32 v36, v36, v92
    v_mfma_f32_32x32x16_bf16 v[176:191], a[60:63], a[72:75], v[176:191]
    v_add_f32 v37, v37, v93
    v_fma_f32 v96, v96, s60, v27
    v_fma_f32 v97, v97, s60, v27
    v_exp_f32 v96, v96
    v_mfma_f32_32x32x16_bf16 v[192:207], a[60:63], a[76:79], v[192:207]
    v_exp_f32 v97, v97
    v_add_f32 v36, v36, v94
    v_add_f32 v37, v37, v95
    v_fma_f32 v98, v98, s60, v27
    v_mfma_f32_32x32x16_bf16 v[208:223], a[64:67], a[68:71], v[208:223]
    buffer_load_dwordx4 v17, s[32:35], s61 offen offset:1024 nt lds
    v_fma_f32 v99, v99, s60, v27
    v_exp_f32 v98, v98
    v_exp_f32 v99, v99
    v_mfma_f32_32x32x16_bf16 v[224:239], a[64:67], a[72:75], v[224:239]
    v_add_f32 v38, v38, v96
    v_add_f32 v39, v39, v97
    v_fma_f32 v100, v100, s60, v27
    v_fma_f32 v101, v101, s60, v27
    v_mfma_f32_32x32x16_bf16 v[240:255], a[64:67], a[76:79], v[240:255]
    s_add_u32 m0, s52, 2048
    s_mov_b32 s61, 8192
    buffer_load_dwordx4 v16, s[32:35], s61 offen offset:0 nt lds
    v_exp_f32 v100, v100
    v_exp_f32 v101, v101
    v_add_f32 v38, v38, v98
    v_add_f32 v39, v39, v99
    s_waitcnt lgkmcnt(0)
    v_mfma_f32_32x32x16_bf16 v[160:175], a[0:3], a[8:11], v[160:175]
    ds_read_b128 a[20:23], v9 offset:0
    ds_read_b128 a[24:27], v9 offset:4096
    ds_read_b128 a[28:31], v3 offset:27648
    ds_read_b128 a[32:35], v3 offset:28672
    ds_read_b128 a[36:39], v3 offset:29696
    v_fma_f32 v102, v102, s60, v27
    v_fma_f32 v103, v103, s60, v27
    v_exp_f32 v102, v102
    v_mfma_f32_32x32x16_bf16 v[176:191], a[0:3], a[12:15], v[176:191]
    v_exp_f32 v103, v103
    v_add_f32 v38, v38, v100
    v_add_f32 v39, v39, v101
    v_fma_f32 v104, v104, s60, v27
    v_mfma_f32_32x32x16_bf16 v[192:207], a[0:3], a[16:19], v[192:207]
    buffer_load_dwordx4 v17, s[32:35], s61 offen offset:1024 nt lds
    v_fma_f32 v105, v105, s60, v27
    v_exp_f32 v104, v104
    v_exp_f32 v105, v105
    v_mfma_f32_32x32x16_bf16 v[208:223], a[4:7], a[8:11], v[208:223]
    v_add_f32 v38, v38, v102
    v_add_f32 v39, v39, v103
    v_fma_f32 v106, v106, s60, v27
    v_fma_f32 v107, v107, s60, v27
    v_mfma_f32_32x32x16_bf16 v[224:239], a[4:7], a[12:15], v[224:239]
    s_add_u32 m0, s52, 4096
    s_mov_b32 s61, 65536
    buffer_load_dwordx4 v16, s[32:35], s61 offen offset:0 nt lds
    v_exp_f32 v106, v106
    v_exp_f32 v107, v107
    v_add_f32 v38, v38, v104
    v_add_f32 v39, v39, v105
    v_mfma_f32_32x32x16_bf16 v[240:255], a[4:7], a[16:19], v[240:255]
    v_fma_f32 v108, v108, s60, v27
    v_fma_f32 v109, v109, s60, v27
    v_exp_f32 v108, v108
    s_waitcnt lgkmcnt(0)
    v_mfma_f32_32x32x16_bf16 v[160:175], a[20:23], a[28:31], v[160:175]
    ds_read_b128 a[40:43], v10 offset:0
    ds_read_b128 a[44:47], v10 offset:4096
    ds_read_b128 a[48:51], v3 offset:30720
    ds_read_b128 a[52:55], v3 offset:31744
    ds_read_b128 a[56:59], v3 offset:32768
    v_exp_f32 v109, v109
    v_add_f32 v38, v38, v106
    v_add_f32 v39, v39, v107
    v_fma_f32 v110, v110, s60, v27
    v_fma_f32 v111, v111, s60, v27
    v_mfma_f32_32x32x16_bf16 v[176:191], a[20:23], a[32:35], v[176:191]
    buffer_load_dwordx4 v17, s[32:35], s61 offen offset:1024 nt lds
    v_exp_f32 v110, v110
    v_exp_f32 v111, v111
    v_add_f32 v38, v38, v108
    v_mfma_f32_32x32x16_bf16 v[192:207], a[20:23], a[36:39], v[192:207]
    v_add_f32 v39, v39, v109
    v_add_f32 v38, v38, v110
    v_add_f32 v39, v39, v111
    v_fma_f32 v112, v112, s60, v25
    v_fma_f32 v113, v113, s60, v25
    v_mfma_f32_32x32x16_bf16 v[208:223], a[24:27], a[28:31], v[208:223]
    s_add_u32 m0, s52, 6144
    s_mov_b32 s61, 73728
    buffer_load_dwordx4 v16, s[32:35], s61 offen offset:0 nt lds
    v_exp_f32 v112, v112
    v_exp_f32 v113, v113
    v_fma_f32 v114, v114, s60, v25
    v_mfma_f32_32x32x16_bf16 v[224:239], a[24:27], a[32:35], v[224:239]
    v_fma_f32 v115, v115, s60, v25
    v_exp_f32 v114, v114
    v_exp_f32 v115, v115
    v_mfma_f32_32x32x16_bf16 v[240:255], a[24:27], a[36:39], v[240:255]
    v_add_f32 v34, v34, v112
    v_add_f32 v35, v35, v113
    v_fma_f32 v116, v116, s60, v25
    v_fma_f32 v117, v117, s60, v25
    s_waitcnt lgkmcnt(0)
    v_mfma_f32_32x32x16_bf16 v[160:175], a[40:43], a[48:51], v[160:175]
    buffer_load_dwordx4 v17, s[32:35], s61 offen offset:1024 nt lds
    ds_read_b128 a[60:63], v11 offset:0
    ds_read_b128 a[64:67], v11 offset:4096
    ds_read_b128 a[68:71], v3 offset:33792
    ds_read_b128 a[72:75], v3 offset:34816
    ds_read_b128 a[76:79], v3 offset:35840
    v_exp_f32 v116, v116
    v_exp_f32 v117, v117
    v_add_f32 v34, v34, v114
    v_add_f32 v35, v35, v115
    v_mfma_f32_32x32x16_bf16 v[176:191], a[40:43], a[52:55], v[176:191]
    v_fma_f32 v118, v118, s60, v25
    v_fma_f32 v119, v119, s60, v25
    v_exp_f32 v118, v118
    v_mfma_f32_32x32x16_bf16 v[192:207], a[40:43], a[56:59], v[192:207]
    v_exp_f32 v119, v119
    v_add_f32 v34, v34, v116
    v_add_f32 v35, v35, v117
    v_fma_f32 v120, v120, s60, v25
    v_fma_f32 v121, v121, s60, v25
    v_mfma_f32_32x32x16_bf16 v[208:223], a[44:47], a[48:51], v[208:223]
    v_exp_f32 v120, v120
    v_exp_f32 v121, v121
    v_add_f32 v34, v34, v118
    v_mfma_f32_32x32x16_bf16 v[224:239], a[44:47], a[52:55], v[224:239]
    v_add_f32 v35, v35, v119
    v_fma_f32 v122, v122, s60, v25
    v_fma_f32 v123, v123, s60, v25
    v_exp_f32 v122, v122
    v_mfma_f32_32x32x16_bf16 v[240:255], a[44:47], a[56:59], v[240:255]
    v_exp_f32 v123, v123
    v_add_f32 v34, v34, v120
    v_add_f32 v35, v35, v121
    v_fma_f32 v124, v124, s60, v25
    s_waitcnt lgkmcnt(0)
    v_mfma_f32_32x32x16_bf16 v[160:175], a[60:63], a[68:71], v[160:175]
    s_add_u32 m0, s53, 0
    s_mov_b32 s61, 131072
    buffer_load_dwordx4 v16, s[32:35], s61 offen offset:0 nt lds
    s_waitcnt vmcnt(9)
    ds_read_b128 a[0:3], v4 offset:8192
    ds_read_b128 a[4:7], v4 offset:12288
    ds_read_b128 a[8:11], v3 offset:36864
    ds_read_b128 a[12:15], v3 offset:37888
    ds_read_b128 a[16:19], v3 offset:38912
    v_fma_f32 v125, v125, s60, v25
    v_exp_f32 v124, v124
    v_exp_f32 v125, v125
    v_mfma_f32_32x32x16_bf16 v[176:191], a[60:63], a[72:75], v[176:191]
    v_add_f32 v34, v34, v122
    v_add_f32 v35, v35, v123
    v_fma_f32 v126, v126, s60, v25
    v_fma_f32 v127, v127, s60, v25
    v_mfma_f32_32x32x16_bf16 v[192:207], a[60:63], a[76:79], v[192:207]
    ds_read_b128 a[20:23], v5 offset:8192
    ds_read_b128 a[24:27], v5 offset:12288
    ds_read_b128 a[28:31], v3 offset:39936
    ds_read_b128 a[32:35], v3 offset:40960
    ds_read_b128 a[36:39], v3 offset:41984
    v_exp_f32 v126, v126
    v_exp_f32 v127, v127
    v_add_f32 v34, v34, v124
    v_add_f32 v35, v35, v125
    v_mfma_f32_32x32x16_bf16 v[208:223], a[64:67], a[68:71], v[208:223]
    buffer_load_dwordx4 v17, s[32:35], s61 offen offset:1024 nt lds
    v_fma_f32 v128, v128, s60, v26
    v_fma_f32 v129, v129, s60, v26
    v_exp_f32 v128, v128
    v_mfma_f32_32x32x16_bf16 v[224:239], a[64:67], a[72:75], v[224:239]
    ds_read_b128 a[40:43], v6 offset:8192
    ds_read_b128 a[44:47], v6 offset:12288
    ds_read_b128 a[48:51], v3 offset:43008
    ds_read_b128 a[52:55], v3 offset:44032
    ds_read_b128 a[56:59], v3 offset:45056
    v_exp_f32 v129, v129
    v_add_f32 v34, v34, v126
    v_add_f32 v35, v35, v127
    v_fma_f32 v130, v130, s60, v26
    v_fma_f32 v131, v131, s60, v26
    v_mfma_f32_32x32x16_bf16 v[240:255], a[64:67], a[76:79], v[240:255]
    s_add_u32 m0, s53, 2048
    s_mov_b32 s61, 139264
    buffer_load_dwordx4 v16, s[32:35], s61 offen offset:0 nt lds
    v_exp_f32 v130, v130
    v_exp_f32 v131, v131
    v_add_f32 v36, v36, v128
    s_waitcnt lgkmcnt(10)
    v_mfma_f32_32x32x16_bf16 v[160:175], a[0:3], a[8:11], v[160:175]
    ds_read_b128 a[60:63], v7 offset:8192
    ds_read_b128 a[64:67], v7 offset:12288
    ds_read_b128 a[68:71], v3 offset:46080
    ds_read_b128 a[72:75], v3 offset:47104
    ds_read_b128 a[76:79], v3 offset:48128
    v_add_f32 v37, v37, v129
    v_fma_f32 v132, v132, s60, v26
    v_fma_f32 v133, v133, s60, v26
    v_exp_f32 v132, v132
    v_mfma_f32_32x32x16_bf16 v[208:223], a[4:7], a[8:11], v[208:223]
    v_exp_f32 v133, v133
    v_add_f32 v36, v36, v130
    v_add_f32 v37, v37, v131
    v_fma_f32 v134, v134, s60, v26
    s_waitcnt lgkmcnt(10)
    v_mfma_f32_32x32x16_bf16 v[160:175], a[20:23], a[28:31], v[160:175]
    buffer_load_dwordx4 v17, s[32:35], s61 offen offset:1024 nt lds
    v_fma_f32 v135, v135, s60, v26
    v_exp_f32 v134, v134
    v_exp_f32 v135, v135
    v_mfma_f32_32x32x16_bf16 v[208:223], a[24:27], a[28:31], v[208:223]
    v_add_f32 v36, v36, v132
    v_add_f32 v37, v37, v133
    v_fma_f32 v136, v136, s60, v26
    v_fma_f32 v137, v137, s60, v26
    s_waitcnt lgkmcnt(5)
    v_mfma_f32_32x32x16_bf16 v[160:175], a[40:43], a[48:51], v[160:175]
    s_add_u32 m0, s53, 4096
    s_mov_b32 s61, 196608
    buffer_load_dwordx4 v16, s[32:35], s61 offen offset:0 nt lds
    v_exp_f32 v136, v136
    v_exp_f32 v137, v137
    v_add_f32 v36, v36, v134
    v_add_f32 v37, v37, v135
    v_mfma_f32_32x32x16_bf16 v[208:223], a[44:47], a[48:51], v[208:223]
    v_fma_f32 v138, v138, s60, v26
    v_fma_f32 v139, v139, s60, v26
    v_exp_f32 v138, v138
    s_waitcnt lgkmcnt(0)
    v_mfma_f32_32x32x16_bf16 v[160:175], a[60:63], a[68:71], v[160:175]
    v_exp_f32 v139, v139
    v_add_f32 v36, v36, v136
    v_add_f32 v37, v37, v137
    v_fma_f32 v140, v140, s60, v26
    v_fma_f32 v141, v141, s60, v26
    v_mfma_f32_32x32x16_bf16 v[208:223], a[64:67], a[68:71], v[208:223]
    buffer_load_dwordx4 v17, s[32:35], s61 offen offset:1024 nt lds
    v_exp_f32 v140, v140
    v_exp_f32 v141, v141
    v_add_f32 v36, v36, v138
    v_mfma_f32_32x32x16_bf16 v[176:191], a[0:3], a[12:15], v[176:191]
    v_add_f32 v37, v37, v139
    v_fma_f32 v142, v142, s60, v26
    v_fma_f32 v143, v143, s60, v26
    v_exp_f32 v142, v142
    v_mfma_f32_32x32x16_bf16 v[224:239], a[4:7], a[12:15], v[224:239]
    s_add_u32 m0, s53, 6144
    s_mov_b32 s61, 204800
    buffer_load_dwordx4 v16, s[32:35], s61 offen offset:0 nt lds
    v_exp_f32 v143, v143
    v_add_f32 v36, v36, v140
    v_add_f32 v37, v37, v141
    v_fma_f32 v144, v144, s60, v27
    v_mfma_f32_32x32x16_bf16 v[176:191], a[20:23], a[32:35], v[176:191]
    v_fma_f32 v145, v145, s60, v27
    v_exp_f32 v144, v144
    v_exp_f32 v145, v145
    v_max3_f32 v28, v28, v160, v161
    v_max3_f32 v28, v28, v162, v163
    v_mfma_f32_32x32x16_bf16 v[224:239], a[24:27], a[32:35], v[224:239]
    v_add_f32 v36, v36, v142
    v_add_f32 v37, v37, v143
    v_fma_f32 v146, v146, s60, v27
    v_fma_f32 v147, v147, s60, v27
    v_max3_f32 v28, v28, v164, v165
    v_max3_f32 v28, v28, v166, v167
    v_max3_f32 v28, v28, v168, v169
    v_mfma_f32_32x32x16_bf16 v[176:191], a[40:43], a[52:55], v[176:191]
    buffer_load_dwordx4 v17, s[32:35], s61 offen offset:1024 nt lds
    v_exp_f32 v146, v146
    v_exp_f32 v147, v147
    v_add_f32 v38, v38, v144
    v_add_f32 v39, v39, v145
    v_max3_f32 v28, v28, v170, v171
    v_max3_f32 v28, v28, v172, v173
    v_max3_f32 v28, v28, v174, v175
    v_mfma_f32_32x32x16_bf16 v[224:239], a[44:47], a[52:55], v[224:239]
    v_fma_f32 v148, v148, s60, v27
    v_fma_f32 v149, v149, s60, v27
    v_exp_f32 v148, v148
    v_max3_f32 v28, v28, v208, v209
    v_max3_f32 v28, v28, v210, v211
    v_mfma_f32_32x32x16_bf16 v[176:191], a[60:63], a[72:75], v[176:191]
    v_exp_f32 v149, v149
    v_add_f32 v38, v38, v146
    v_add_f32 v39, v39, v147
    v_fma_f32 v150, v150, s60, v27
    v_fma_f32 v151, v151, s60, v27
    v_max3_f32 v28, v28, v212, v213
    v_max3_f32 v28, v28, v214, v215
    v_max3_f32 v28, v28, v216, v217
    v_mfma_f32_32x32x16_bf16 v[224:239], a[64:67], a[72:75], v[224:239]
    v_exp_f32 v150, v150
    v_exp_f32 v151, v151
    v_add_f32 v38, v38, v148
    v_max3_f32 v28, v28, v218, v219
    v_max3_f32 v28, v28, v220, v221
    v_max3_f32 v28, v28, v222, v223
    v_mfma_f32_32x32x16_bf16 v[192:207], a[0:3], a[16:19], v[192:207]
    v_add_f32 v39, v39, v149
    v_fma_f32 v152, v152, s60, v27
    v_fma_f32 v153, v153, s60, v27
    v_exp_f32 v152, v152
    v_mfma_f32_32x32x16_bf16 v[240:255], a[4:7], a[16:19], v[240:255]
    v_exp_f32 v153, v153
    v_add_f32 v38, v38, v150
    v_add_f32 v39, v39, v151
    v_fma_f32 v154, v154, s60, v27
    v_mfma_f32_32x32x16_bf16 v[192:207], a[20:23], a[36:39], v[192:207]
    v_fma_f32 v155, v155, s60, v27
    v_exp_f32 v154, v154
    v_exp_f32 v155, v155
    v_max3_f32 v29, v29, v176, v177
    v_max3_f32 v29, v29, v178, v179
    v_mfma_f32_32x32x16_bf16 v[240:255], a[24:27], a[36:39], v[240:255]
    v_add_f32 v38, v38, v152
    v_add_f32 v39, v39, v153
    v_fma_f32 v156, v156, s60, v27
    v_fma_f32 v157, v157, s60, v27
    v_max3_f32 v29, v29, v180, v181
    v_max3_f32 v29, v29, v182, v183
    v_max3_f32 v29, v29, v184, v185
    v_mfma_f32_32x32x16_bf16 v[192:207], a[40:43], a[56:59], v[192:207]
    v_exp_f32 v156, v156
    v_exp_f32 v157, v157
    v_add_f32 v38, v38, v154
    v_add_f32 v39, v39, v155
    v_max3_f32 v29, v29, v186, v187
    v_max3_f32 v29, v29, v188, v189
    v_max3_f32 v29, v29, v190, v191
    v_mfma_f32_32x32x16_bf16 v[240:255], a[44:47], a[56:59], v[240:255]
    v_fma_f32 v158, v158, s60, v27
    v_fma_f32 v159, v159, s60, v27
    v_exp_f32 v158, v158
    v_max3_f32 v29, v29, v224, v225
    v_max3_f32 v29, v29, v226, v227
    v_mfma_f32_32x32x16_bf16 v[192:207], a[60:63], a[76:79], v[192:207]
    v_exp_f32 v159, v159
    v_add_f32 v38, v38, v156
    v_add_f32 v39, v39, v157
    v_add_f32 v38, v38, v158
    v_add_f32 v39, v39, v159
    v_max3_f32 v29, v29, v228, v229
    v_max3_f32 v29, v29, v230, v231
    v_max3_f32 v29, v29, v232, v233
    v_mfma_f32_32x32x16_bf16 v[240:255], a[64:67], a[76:79], v[240:255]
    v_max3_f32 v29, v29, v234, v235
    v_max3_f32 v29, v29, v236, v237
    v_max3_f32 v29, v29, v238, v239
    s_lshl_b32 s56, s49, 4
    v_mov_b32 v60, s56
    v_mov_b32 v44, 0
    s_mov_b64 exec, s[98:99]
    global_load_dword v44, v60, s[16:17]
    s_mov_b64 exec, -1
    s_add_u32 m0, s52, 8192
    s_mov_b32 s61, 16384
    buffer_load_dwordx4 v16, s[32:35], s61 offen offset:0 nt lds
    buffer_load_dwordx4 v17, s[32:35], s61 offen offset:1024 nt lds
    s_nop 7
    v_max3_f32 v30, v30, v192, v193
    v_max3_f32 v30, v30, v194, v195
    v_max3_f32 v30, v30, v196, v197
    v_max3_f32 v30, v30, v198, v199
    v_max3_f32 v30, v30, v200, v201
    v_max3_f32 v30, v30, v202, v203
    v_max3_f32 v30, v30, v204, v205
    v_max3_f32 v30, v30, v206, v207
    v_max3_f32 v30, v30, v240, v241
    v_max3_f32 v30, v30, v242, v243
    v_max3_f32 v30, v30, v244, v245
    v_max3_f32 v30, v30, v246, v247
    v_max3_f32 v30, v30, v248, v249
    v_max3_f32 v30, v30, v250, v251
    v_max3_f32 v30, v30, v252, v253
    v_max3_f32 v30, v30, v254, v255
    v_mov_b32 v56, v28
    v_mov_b32 v57, v29
    v_mov_b32 v58, v30
    s_nop 1
    v_permlane32_swap_b32 v28, v56
    v_permlane32_swap_b32 v29, v57
    v_permlane32_swap_b32 v30, v58
    s_nop 0
    v_max_f32 v28, v28, v56
    v_max_f32 v29, v29, v57
    v_max_f32 v30, v30, v58
    ds_write_b32 v24, v28 offset:0
    ds_write_b32 v24, v29 offset:512
    ds_write_b32 v24, v30 offset:1024
    s_add_u32 m0, s52, 10240
    s_mov_b32 s61, 24576
    buffer_load_dwordx4 v16, s[32:35], s61 offen offset:0 nt lds
    buffer_load_dwordx4 v17, s[32:35], s61 offen offset:1024 nt lds
    s_waitcnt lgkmcnt(0)
    s_barrier
    ds_read_b128 v[48:51], v23 offset:0
    ds_read_b128 v[52:55], v23 offset:512
    ds_read_b128 v[56:59], v23 offset:1024
    s_add_u32 m0, s52, 12288
    s_mov_b32 s61, 81920
    buffer_load_dwordx4 v16, s[32:35], s61 offen offset:0 nt lds
    buffer_load_dwordx4 v17, s[32:35], s61 offen offset:1024 nt lds
    s_add_u32 m0, s52, 14336
    s_mov_b32 s61, 90112
    buffer_load_dwordx4 v16, s[32:35], s61 offen offset:0 nt lds
    buffer_load_dwordx4 v17, s[32:35], s61 offen offset:1024 nt lds
    s_waitcnt lgkmcnt(0)
    v_max3_f32 v28, v48, v49, v50
    v_max_f32 v28, v28, v51
    v_mul_f32 v28, s60, v28
    v_sub_f32 v28, 0, v28
    v_max3_f32 v29, v52, v53, v54
    v_max_f32 v29, v29, v55
    v_mul_f32 v29, s60, v29
    v_sub_f32 v29, 0, v29
    v_max3_f32 v30, v56, v57, v58
    v_max_f32 v30, v30, v59
    v_mul_f32 v30, s60, v30
    v_sub_f32 v30, 0, v30
    v_sub_f32 v31, v28, v25
    v_sub_f32 v32, v29, v26
    v_sub_f32 v33, v30, v27
    v_exp_f32 v31, v31
    v_exp_f32 v32, v32
    v_exp_f32 v33, v33
    s_nop 0
    v_mul_f32 v34, v34, v31
    v_mul_f32 v35, v35, v31
    v_mul_f32 v36, v36, v32
    v_mul_f32 v37, v37, v32
    v_mul_f32 v38, v38, v33
    v_mul_f32 v39, v39, v33
    v_pk_mul_f32 v[64:65], v[64:65], v[30:31] op_sel:[0,1] op_sel_hi:[1,1]
    v_pk_mul_f32 v[66:67], v[66:67], v[30:31] op_sel:[0,1] op_sel_hi:[1,1]
    v_pk_mul_f32 v[68:69], v[68:69], v[30:31] op_sel:[0,1] op_sel_hi:[1,1]
    v_pk_mul_f32 v[70:71], v[70:71], v[30:31] op_sel:[0,1] op_sel_hi:[1,1]
    v_cvt_pk_bf16_f32 v48, v64, v65
    v_pk_mul_f32 v[72:73], v[72:73], v[30:31] op_sel:[0,1] op_sel_hi:[1,1]
    v_cvt_pk_bf16_f32 v49, v66, v67
    v_pk_mul_f32 v[74:75], v[74:75], v[30:31] op_sel:[0,1] op_sel_hi:[1,1]
    v_cvt_pk_bf16_f32 v50, v68, v69
    v_pk_mul_f32 v[76:77], v[76:77], v[30:31] op_sel:[0,1] op_sel_hi:[1,1]
    v_cvt_pk_bf16_f32 v51, v70, v71
    v_pk_mul_f32 v[78:79], v[78:79], v[30:31] op_sel:[0,1] op_sel_hi:[1,1]
    ds_write_b128 v22, v[48:51] offset:0
    v_cvt_pk_bf16_f32 v52, v72, v73
    v_pk_mul_f32 v[80:81], v[80:81], v[32:33] op_sel_hi:[1,0]
    v_cvt_pk_bf16_f32 v53, v74, v75
    v_pk_mul_f32 v[82:83], v[82:83], v[32:33] op_sel_hi:[1,0]
    v_cvt_pk_bf16_f32 v54, v76, v77
    v_pk_mul_f32 v[84:85], v[84:85], v[32:33] op_sel_hi:[1,0]
    v_cvt_pk_bf16_f32 v55, v78, v79
    v_pk_mul_f32 v[86:87], v[86:87], v[32:33] op_sel_hi:[1,0]
    ds_write_b128 v22, v[52:55] offset:3072
    v_cvt_pk_bf16_f32 v48, v80, v81
    v_pk_mul_f32 v[88:89], v[88:89], v[32:33] op_sel_hi:[1,0]
    v_cvt_pk_bf16_f32 v49, v82, v83
    v_pk_mul_f32 v[90:91], v[90:91], v[32:33] op_sel_hi:[1,0]
    v_cvt_pk_bf16_f32 v50, v84, v85
    v_pk_mul_f32 v[92:93], v[92:93], v[32:33] op_sel_hi:[1,0]
    v_cvt_pk_bf16_f32 v51, v86, v87
    v_pk_mul_f32 v[94:95], v[94:95], v[32:33] op_sel_hi:[1,0]
    ds_write_b128 v22, v[48:51] offset:1024
    v_cvt_pk_bf16_f32 v52, v88, v89
    v_pk_mul_f32 v[96:97], v[96:97], v[32:33] op_sel:[0,1] op_sel_hi:[1,1]
    v_cvt_pk_bf16_f32 v53, v90, v91
    v_pk_mul_f32 v[98:99], v[98:99], v[32:33] op_sel:[0,1] op_sel_hi:[1,1]
    v_cvt_pk_bf16_f32 v54, v92, v93
    v_pk_mul_f32 v[100:101], v[100:101], v[32:33] op_sel:[0,1] op_sel_hi:[1,1]
    v_cvt_pk_bf16_f32 v55, v94, v95
    v_pk_mul_f32 v[102:103], v[102:103], v[32:33] op_sel:[0,1] op_sel_hi:[1,1]
    ds_write_b128 v22, v[52:55] offset:4096
    v_cvt_pk_bf16_f32 v48, v96, v97
    v_pk_mul_f32 v[104:105], v[104:105], v[32:33] op_sel:[0,1] op_sel_hi:[1,1]
    v_cvt_pk_bf16_f32 v49, v98, v99
    v_pk_mul_f32 v[106:107], v[106:107], v[32:33] op_sel:[0,1] op_sel_hi:[1,1]
    v_cvt_pk_bf16_f32 v50, v100, v101
    v_pk_mul_f32 v[108:109], v[108:109], v[32:33] op_sel:[0,1] op_sel_hi:[1,1]
    v_cvt_pk_bf16_f32 v51, v102, v103
    v_pk_mul_f32 v[110:111], v[110:111], v[32:33] op_sel:[0,1] op_sel_hi:[1,1]
    ds_write_b128 v22, v[48:51] offset:2048
    v_cvt_pk_bf16_f32 v52, v104, v105
    v_cvt_pk_bf16_f32 v53, v106, v107
    v_cvt_pk_bf16_f32 v54, v108, v109
    v_cvt_pk_bf16_f32 v55, v110, v111
    ds_write_b128 v22, v[52:55] offset:5120
    s_waitcnt vmcnt(23)
    ds_read_b64_tr_b16 a[0:1], v18 offset:0
    ds_read_b64_tr_b16 a[2:3], v18 offset:1024
    ds_read_b64_tr_b16 a[4:5], v19 offset:0
    ds_read_b64_tr_b16 a[6:7], v19 offset:1024
    s_waitcnt lgkmcnt(4)
    s_barrier
    ds_read_b128 a[8:11], v3 offset:0
    ds_read_b128 a[12:15], v3 offset:1024
    ds_read_b128 a[16:19], v3 offset:2048
    s_waitcnt lgkmcnt(0)
    v_mfma_f32_32x32x16_bf16 a[160:175], a[0:3], a[8:11], 0
    s_waitcnt vmcnt(21)
    ds_read_b64_tr_b16 a[20:21], v18 offset:2048
    ds_read_b64_tr_b16 a[22:23], v18 offset:3072
    ds_read_b64_tr_b16 a[24:25], v19 offset:2048
    ds_read_b64_tr_b16 a[26:27], v19 offset:3072
    ds_read_b128 a[28:31], v3 offset:3072
    v_mul_f32 v112, v112, v31
    v_mul_f32 v113, v113, v31
    v_fma_f32 v160, v160, s60, v28
    v_fma_f32 v161, v161, s60, v28
    v_mfma_f32_32x32x16_bf16 a[176:191], a[0:3], a[12:15], 0
    ds_read_b128 a[32:35], v3 offset:4096
    ds_read_b128 a[36:39], v3 offset:5120
    v_cvt_pk_bf16_f32 v48, v112, v113
    v_mul_f32 v114, v114, v31
    v_exp_f32 v160, v160
    v_exp_f32 v161, v161
    v_mfma_f32_32x32x16_bf16 a[192:207], a[0:3], a[16:19], 0
    v_mul_f32 v115, v115, v31
    v_cvt_pk_bf16_f32 v49, v114, v115
    v_mul_f32 v116, v116, v31
    v_fma_f32 v162, v162, s60, v28
    v_fma_f32 v163, v163, s60, v28
    v_mfma_f32_32x32x16_bf16 a[208:223], a[4:7], a[8:11], 0
    s_add_u32 m0, s52, 0
    s_mov_b32 s61, 147456
    buffer_load_dwordx4 v16, s[32:35], s61 offen offset:0 nt lds
    v_mul_f32 v117, v117, v31
    v_cvt_pk_bf16_f32 v50, v116, v117
    v_exp_f32 v162, v162
    v_exp_f32 v163, v163
    v_mfma_f32_32x32x16_bf16 a[224:239], a[4:7], a[12:15], 0
    v_mul_f32 v118, v118, v31
    v_mul_f32 v119, v119, v31
    v_add_f32 v34, v34, v160
    v_add_f32 v35, v35, v161
    v_fma_f32 v164, v164, s60, v28
    v_fma_f32 v165, v165, s60, v28
    v_mfma_f32_32x32x16_bf16 a[240:255], a[4:7], a[16:19], 0
    buffer_load_dwordx4 v17, s[32:35], s61 offen offset:1024 nt lds
    v_cvt_pk_bf16_f32 v51, v118, v119
    ds_write_b128 v22, v[48:51] offset:24576
    v_exp_f32 v164, v164
    s_waitcnt lgkmcnt(1)
    v_mfma_f32_32x32x16_bf16 a[160:175], a[20:23], a[28:31], a[160:175]
    s_waitcnt vmcnt(21)
    ds_read_b64_tr_b16 a[40:41], v18 offset:4096
    ds_read_b64_tr_b16 a[42:43], v18 offset:5120
    ds_read_b64_tr_b16 a[44:45], v19 offset:4096
    ds_read_b64_tr_b16 a[46:47], v19 offset:5120
    ds_read_b128 a[48:51], v3 offset:6144
    v_exp_f32 v165, v165
    v_add_f32 v34, v34, v162
    v_add_f32 v35, v35, v163
    v_mfma_f32_32x32x16_bf16 a[176:191], a[20:23], a[32:35], a[176:191]
    ds_read_b128 a[52:55], v3 offset:7168
    ds_read_b128 a[56:59], v3 offset:8192
    v_mul_f32 v120, v120, v31
    v_mul_f32 v121, v121, v31
    v_fma_f32 v166, v166, s60, v28
    v_fma_f32 v167, v167, s60, v28
    v_mfma_f32_32x32x16_bf16 a[192:207], a[20:23], a[36:39], a[192:207]
    s_add_u32 m0, s52, 2048
    s_mov_b32 s61, 155648
    buffer_load_dwordx4 v16, s[32:35], s61 offen offset:0 nt lds
    v_lshrrev_b32 v56, 3, v1
    v_cvt_pk_bf16_f32 v52, v120, v121
    v_mul_f32 v122, v122, v31
    v_exp_f32 v166, v166
    v_exp_f32 v167, v167
    v_add_f32 v34, v34, v164
    v_mfma_f32_32x32x16_bf16 a[208:223], a[24:27], a[28:31], a[208:223]
    v_mul_f32 v123, v123, v31
    v_cvt_pk_bf16_f32 v53, v122, v123
    v_mul_f32 v124, v124, v31
    v_add_f32 v35, v35, v165
    v_fma_f32 v168, v168, s60, v28
    v_fma_f32 v169, v169, s60, v28
    v_mfma_f32_32x32x16_bf16 a[224:239], a[24:27], a[32:35], a[224:239]
    buffer_load_dwordx4 v17, s[32:35], s61 offen offset:1024 nt lds
    v_mul_f32 v125, v125, v31
    v_cvt_pk_bf16_f32 v54, v124, v125
    v_exp_f32 v168, v168
    v_mfma_f32_32x32x16_bf16 a[240:255], a[24:27], a[36:39], a[240:255]
    v_bfe_u32 v57, v1, 4, 2
    v_mul_f32 v126, v126, v31
    v_mul_f32 v127, v127, v31
    v_exp_f32 v169, v169
    v_add_f32 v34, v34, v166
    v_add_f32 v35, v35, v167
    s_waitcnt lgkmcnt(0)
    v_mfma_f32_32x32x16_bf16 a[160:175], a[40:43], a[48:51], a[160:175]
    s_waitcnt vmcnt(21)
    ds_read_b64_tr_b16 a[60:61], v18 offset:6144
    ds_read_b64_tr_b16 a[62:63], v18 offset:7168
    ds_read_b64_tr_b16 a[64:65], v19 offset:6144
    ds_read_b64_tr_b16 a[66:67], v19 offset:7168
    ds_read_b128 a[68:71], v3 offset:9216
    v_cvt_pk_bf16_f32 v55, v126, v127
    ds_write_b128 v22, v[52:55] offset:27648
    v_fma_f32 v170, v170, s60, v28
    v_fma_f32 v171, v171, s60, v28
    v_mfma_f32_32x32x16_bf16 a[176:191], a[40:43], a[52:55], a[176:191]
    s_add_u32 m0, s52, 4096
    s_mov_b32 s61, 212992
    buffer_load_dwordx4 v16, s[32:35], s61 offen offset:0 nt lds
    ds_read_b128 a[72:75], v3 offset:10240
    ds_read_b128 a[76:79], v3 offset:11264
    v_exp_f32 v170, v170
    v_exp_f32 v171, v171
    v_add_f32 v34, v34, v168
    v_mfma_f32_32x32x16_bf16 a[192:207], a[40:43], a[56:59], a[192:207]
    v_lshlrev_b32 v57, 1, v57
    v_mul_f32 v128, v128, v32
    v_mul_f32 v129, v129, v32
    v_add_f32 v35, v35, v169
    v_fma_f32 v172, v172, s60, v28
    v_fma_f32 v173, v173, s60, v28
    v_mfma_f32_32x32x16_bf16 a[208:223], a[44:47], a[48:51], a[208:223]
    s_and_b32 s54, s49, 7
    s_cmp_eq_u32 s54, 7
    s_cselect_b32 s54, 0, s54
    s_lshl_b32 s56, s54, 2
    s_mov_b32 s96, 0x06543210
    s_mov_b32 s97, 0
    s_lshl_b64 s[96:97], s[96:97], 28
    s_or_b32 s96, s96, 0x06543210
    s_lshr_b64 s[96:97], s[96:97], s56
    s_bfe_u32 s56, s96, 0x40000
    s_lshl_b32 s62, s56, 7
    s_bfe_u32 s56, s96, 0x40004
    s_lshl_b32 s63, s56, 7
    s_bfe_u32 s56, s96, 0x40008
    s_lshl_b32 s64, s56, 7
    s_bfe_u32 s56, s96, 0x4000c
    s_lshl_b32 s65, s56, 7
    s_bfe_u32 s56, s96, 0x40010
    s_lshl_b32 s66, s56, 7
    s_bfe_u32 s56, s96, 0x40014
    s_lshl_b32 s67, s56, 7
    s_bfe_u32 s56, s96, 0x40018
    s_lshl_b32 s68, s56, 7
    v_cvt_pk_bf16_f32 v48, v128, v129
    v_mul_f32 v130, v130, v32
    v_exp_f32 v172, v172
    v_mfma_f32_32x32x16_bf16 a[224:239], a[44:47], a[52:55], a[224:239]
    buffer_load_dwordx4 v17, s[32:35], s61 offen offset:1024 nt lds
    v_mul_f32 v131, v131, v32
    v_cvt_pk_bf16_f32 v49, v130, v131
    v_mul_f32 v132, v132, v32
    v_exp_f32 v173, v173
    v_add_f32 v34, v34, v170
    v_add_f32 v35, v35, v171
    v_mfma_f32_32x32x16_bf16 a[240:255], a[44:47], a[56:59], a[240:255]
    v_and_b32 v58, 7, v1
    v_mul_f32 v133, v133, v32
    v_cvt_pk_bf16_f32 v50, v132, v133
    v_fma_f32 v174, v174, s60, v28
    v_fma_f32 v175, v175, s60, v28
    v_exp_f32 v174, v174
    s_waitcnt lgkmcnt(0)
    v_mfma_f32_32x32x16_bf16 a[160:175], a[60:63], a[68:71], a[160:175]
    s_waitcnt vmcnt(21)
    ds_read_b64_tr_b16 a[0:1], v20 offset:0
    ds_read_b64_tr_b16 a[2:3], v20 offset:1024
    ds_read_b64_tr_b16 a[4:5], v21 offset:0
    ds_read_b64_tr_b16 a[6:7], v21 offset:1024
    ds_read_b128 a[8:11], v3 offset:12288
    v_mul_f32 v134, v134, v32
    v_mul_f32 v135, v135, v32
    v_exp_f32 v175, v175
    v_add_f32 v34, v34, v172
    v_mfma_f32_32x32x16_bf16 a[176:191], a[60:63], a[72:75], a[176:191]
    s_add_u32 m0, s52, 6144
    s_mov_b32 s61, 221184
    buffer_load_dwordx4 v16, s[32:35], s61 offen offset:0 nt lds
    ds_read_b128 a[12:15], v3 offset:13312
    ds_read_b128 a[16:19], v3 offset:14336
    v_cvt_pk_bf16_f32 v51, v134, v135
    ds_write_b128 v22, v[48:51] offset:25600
    v_add_f32 v35, v35, v173
    v_fma_f32 v176, v176, s60, v29
    v_fma_f32 v177, v177, s60, v29
    v_mfma_f32_32x32x16_bf16 a[192:207], a[60:63], a[76:79], a[192:207]
    v_xor_b32 v58, v58, v57
    v_exp_f32 v176, v176
    v_mul_f32 v136, v136, v32
    v_mul_f32 v137, v137, v32
    v_mfma_f32_32x32x16_bf16 a[208:223], a[64:67], a[68:71], a[208:223]
    v_exp_f32 v177, v177
    v_add_f32 v34, v34, v174
    v_add_f32 v35, v35, v175
    v_mul_u32_u24 v56, 896, v56
    v_mfma_f32_32x32x16_bf16 a[224:239], a[64:67], a[72:75], a[224:239]
    buffer_load_dwordx4 v17, s[32:35], s61 offen offset:1024 nt lds
    v_cvt_pk_bf16_f32 v52, v136, v137
    v_mul_f32 v138, v138, v32
    v_fma_f32 v178, v178, s60, v29
    v_fma_f32 v179, v179, s60, v29
    v_exp_f32 v178, v178
    v_mfma_f32_32x32x16_bf16 a[240:255], a[64:67], a[76:79], a[240:255]
    v_mul_f32 v139, v139, v32
    v_cvt_pk_bf16_f32 v53, v138, v139
    v_mul_f32 v140, v140, v32
    v_exp_f32 v179, v179
    v_add_f32 v36, v36, v176
    s_waitcnt lgkmcnt(1)
    v_mfma_f32_32x32x16_bf16 a[160:175], a[0:3], a[8:11], a[160:175]
    s_waitcnt vmcnt(21)
    ds_read_b64_tr_b16 a[20:21], v20 offset:2048
    ds_read_b64_tr_b16 a[22:23], v20 offset:3072
    ds_read_b64_tr_b16 a[24:25], v21 offset:2048
    ds_read_b64_tr_b16 a[26:27], v21 offset:3072
    ds_read_b128 a[28:31], v3 offset:15360
    v_mul_f32 v141, v141, v32
    v_cvt_pk_bf16_f32 v54, v140, v141
    v_add_f32 v37, v37, v177
    v_fma_f32 v180, v180, s60, v29
    v_fma_f32 v181, v181, s60, v29
    v_mfma_f32_32x32x16_bf16 a[176:191], a[0:3], a[12:15], a[176:191]
    s_add_u32 m0, s53, 0
    s_mov_b32 s61, 32768
    buffer_load_dwordx4 v16, s[32:35], s61 offen offset:0 nt lds
    v_lshl_add_u32 v12, v58, 4, v56
    ds_read_b128 a[32:35], v3 offset:16384
    ds_read_b128 a[36:39], v3 offset:17408
    v_mul_f32 v142, v142, v32
    v_mul_f32 v143, v143, v32
    v_exp_f32 v180, v180
    v_mfma_f32_32x32x16_bf16 a[192:207], a[0:3], a[16:19], a[192:207]
    v_cvt_pk_bf16_f32 v55, v142, v143
    ds_write_b128 v22, v[52:55] offset:28672
    v_exp_f32 v181, v181
    v_add_f32 v36, v36, v178
    v_add_f32 v37, v37, v179
    v_fma_f32 v182, v182, s60, v29
    v_mfma_f32_32x32x16_bf16 a[208:223], a[4:7], a[8:11], a[208:223]
    v_fma_f32 v183, v183, s60, v29
    v_exp_f32 v182, v182
    v_add_u32 v13, 6144, v12
    v_mul_f32 v144, v144, v33
    v_mfma_f32_32x32x16_bf16 a[224:239], a[4:7], a[12:15], a[224:239]
    buffer_load_dwordx4 v17, s[32:35], s61 offen offset:1024 nt lds
    v_mul_f32 v145, v145, v33
    v_exp_f32 v183, v183
    v_add_f32 v36, v36, v180
    v_mfma_f32_32x32x16_bf16 a[240:255], a[4:7], a[16:19], a[240:255]
    v_cvt_pk_bf16_f32 v48, v144, v145
    v_mul_f32 v146, v146, v33
    v_add_f32 v37, v37, v181
    v_fma_f32 v184, v184, s60, v29
    v_fma_f32 v185, v185, s60, v29
    s_waitcnt lgkmcnt(1)
    v_mfma_f32_32x32x16_bf16 a[160:175], a[20:23], a[28:31], a[160:175]
    s_waitcnt vmcnt(21)
    ds_read_b64_tr_b16 a[40:41], v20 offset:4096
    ds_read_b64_tr_b16 a[42:43], v20 offset:5120
    ds_read_b64_tr_b16 a[44:45], v21 offset:4096
    ds_read_b64_tr_b16 a[46:47], v21 offset:5120
    ds_read_b128 a[48:51], v3 offset:18432
    v_mul_f32 v147, v147, v33
    v_cvt_pk_bf16_f32 v49, v146, v147
    v_mul_f32 v148, v148, v33
    v_exp_f32 v184, v184
    v_exp_f32 v185, v185
    v_mfma_f32_32x32x16_bf16 a[176:191], a[20:23], a[32:35], a[176:191]
    s_add_u32 m0, s53, 2048
    s_mov_b32 s61, 40960
    buffer_load_dwordx4 v16, s[32:35], s61 offen offset:0 nt lds
    v_add_u32 v14, 12288, v12
    ds_read_b128 a[52:55], v3 offset:19456
    ds_read_b128 a[56:59], v3 offset:20480
    v_mul_f32 v149, v149, v33
    v_cvt_pk_bf16_f32 v50, v148, v149
    v_add_f32 v36, v36, v182
    v_add_f32 v37, v37, v183
    v_fma_f32 v186, v186, s60, v29
    v_mfma_f32_32x32x16_bf16 a[192:207], a[20:23], a[36:39], a[192:207]
    v_mul_f32 v150, v150, v33
    v_mul_f32 v151, v151, v33
    v_fma_f32 v187, v187, s60, v29
    v_exp_f32 v186, v186
    v_mfma_f32_32x32x16_bf16 a[208:223], a[24:27], a[28:31], a[208:223]
    v_cvt_pk_bf16_f32 v51, v150, v151
    ds_write_b128 v22, v[48:51] offset:26624
    v_exp_f32 v187, v187
    v_add_f32 v36, v36, v184
    v_mfma_f32_32x32x16_bf16 a[224:239], a[24:27], a[32:35], a[224:239]
    buffer_load_dwordx4 v17, s[32:35], s61 offen offset:1024 nt lds
    v_add_u32 v15, 18432, v12
    v_add_f32 v37, v37, v185
    v_fma_f32 v188, v188, s60, v29
    v_fma_f32 v189, v189, s60, v29
    v_mfma_f32_32x32x16_bf16 a[240:255], a[24:27], a[36:39], a[240:255]
    v_mul_f32 v152, v152, v33
    v_mul_f32 v153, v153, v33
    v_exp_f32 v188, v188
    v_exp_f32 v189, v189
    s_waitcnt lgkmcnt(1)
    v_mfma_f32_32x32x16_bf16 a[160:175], a[40:43], a[48:51], a[160:175]
    s_mul_i32 s55, s48, 57344
    s_waitcnt vmcnt(21)
    ds_read_b64_tr_b16 a[60:61], v20 offset:6144
    ds_read_b64_tr_b16 a[62:63], v20 offset:7168
    ds_read_b64_tr_b16 a[64:65], v21 offset:6144
    ds_read_b64_tr_b16 a[66:67], v21 offset:7168
    ds_read_b128 a[68:71], v3 offset:21504
    v_cvt_pk_bf16_f32 v52, v152, v153
    v_mul_f32 v154, v154, v33
    v_add_f32 v36, v36, v186
    v_add_f32 v37, v37, v187
    v_fma_f32 v190, v190, s60, v29
    v_mfma_f32_32x32x16_bf16 a[176:191], a[40:43], a[52:55], a[176:191]
    s_add_u32 m0, s53, 4096
    s_mov_b32 s61, 98304
    buffer_load_dwordx4 v16, s[32:35], s61 offen offset:0 nt lds
    ds_read_b128 a[72:75], v3 offset:22528
    ds_read_b128 a[76:79], v3 offset:23552
    v_mul_f32 v155, v155, v33
    v_cvt_pk_bf16_f32 v53, v154, v155
    v_mul_f32 v156, v156, v33
    v_fma_f32 v191, v191, s60, v29
    v_exp_f32 v190, v190
    v_mfma_f32_32x32x16_bf16 a[192:207], a[40:43], a[56:59], a[192:207]
    v_mul_f32 v157, v157, v33
    v_cvt_pk_bf16_f32 v54, v156, v157
    v_exp_f32 v191, v191
    v_add_f32 v36, v36, v188
    v_mfma_f32_32x32x16_bf16 a[208:223], a[44:47], a[48:51], a[208:223]
    v_mul_f32 v158, v158, v33
    v_mul_f32 v159, v159, v33
    v_add_f32 v37, v37, v189
    v_fma_f32 v192, v192, s60, v30
    v_fma_f32 v193, v193, s60, v30
    v_mfma_f32_32x32x16_bf16 a[224:239], a[44:47], a[52:55], a[224:239]
    buffer_load_dwordx4 v17, s[32:35], s61 offen offset:1024 nt lds
    v_cvt_pk_bf16_f32 v55, v158, v159
    ds_write_b128 v22, v[52:55] offset:29696
    v_exp_f32 v192, v192
    v_exp_f32 v193, v193
    v_mfma_f32_32x32x16_bf16 a[240:255], a[44:47], a[56:59], a[240:255]
    v_add_f32 v36, v36, v190
    v_add_f32 v37, v37, v191
    v_fma_f32 v194, v194, s60, v30
    v_fma_f32 v195, v195, s60, v30
    s_waitcnt lgkmcnt(0)
    s_barrier
    v_mfma_f32_32x32x16_bf16 a[160:175], a[60:63], a[68:71], a[160:175]
    s_waitcnt vmcnt(20)
    ds_read_b64_tr_b16 a[0:1], v18 offset:8192
    ds_read_b64_tr_b16 a[2:3], v18 offset:9216
    ds_read_b64_tr_b16 a[4:5], v19 offset:8192
    ds_read_b64_tr_b16 a[6:7], v19 offset:9216
    ds_read_b128 a[8:11], v3 offset:24576
    v_exp_f32 v194, v194
    v_mfma_f32_32x32x16_bf16 a[176:191], a[60:63], a[72:75], a[176:191]
    s_add_u32 m0, s53, 6144
    s_mov_b32 s61, 106496
    buffer_load_dwordx4 v16, s[32:35], s61 offen offset:0 nt lds
    ds_read_b128 a[12:15], v3 offset:25600
    ds_read_b128 a[16:19], v3 offset:26624
    v_exp_f32 v195, v195
    v_add_f32 v38, v38, v192
    v_cvt_pk_bf16_f32 v48, v160, v161
    v_cvt_pk_bf16_f32 v49, v162, v163
    v_mfma_f32_32x32x16_bf16 a[192:207], a[60:63], a[76:79], a[192:207]
    v_add_f32 v39, v39, v193
    v_fma_f32 v196, v196, s60, v30
    v_fma_f32 v197, v197, s60, v30
    v_cvt_pk_bf16_f32 v50, v164, v165
    v_cvt_pk_bf16_f32 v51, v166, v167
    v_mfma_f32_32x32x16_bf16 a[208:223], a[64:67], a[68:71], a[208:223]
    v_exp_f32 v196, v196
    v_exp_f32 v197, v197
    ds_write_b128 v22, v[48:51] offset:0
    v_mfma_f32_32x32x16_bf16 a[224:239], a[64:67], a[72:75], a[224:239]
    buffer_load_dwordx4 v17, s[32:35], s61 offen offset:1024 nt lds
    v_add_f32 v38, v38, v194
    v_add_f32 v39, v39, v195
    v_fma_f32 v198, v198, s60, v30
    v_fma_f32 v199, v199, s60, v30
    v_mfma_f32_32x32x16_bf16 a[240:255], a[64:67], a[76:79], a[240:255]
    v_exp_f32 v198, v198
    v_exp_f32 v199, v199
    v_add_f32 v38, v38, v196
    s_waitcnt lgkmcnt(1)
    v_mfma_f32_32x32x16_bf16 a[160:175], a[0:3], a[8:11], a[160:175]
    s_waitcnt vmcnt(20)
    ds_read_b64_tr_b16 a[20:21], v18 offset:10240
    ds_read_b64_tr_b16 a[22:23], v18 offset:11264
    ds_read_b64_tr_b16 a[24:25], v19 offset:10240
    ds_read_b64_tr_b16 a[26:27], v19 offset:11264
    ds_read_b128 a[28:31], v3 offset:27648
    v_add_f32 v39, v39, v197
    v_mfma_f32_32x32x16_bf16 a[176:191], a[0:3], a[12:15], a[176:191]
    s_add_u32 m0, s52, 8192
    s_mov_b32 s61, 163840
    buffer_load_dwordx4 v16, s[32:35], s61 offen offset:0 nt lds
    ds_read_b128 a[32:35], v3 offset:28672
    ds_read_b128 a[36:39], v3 offset:29696
    v_fma_f32 v200, v200, s60, v30
    v_fma_f32 v201, v201, s60, v30
    v_cvt_pk_bf16_f32 v52, v168, v169
    v_cvt_pk_bf16_f32 v53, v170, v171
    v_mfma_f32_32x32x16_bf16 a[192:207], a[0:3], a[16:19], a[192:207]
    v_exp_f32 v200, v200
    v_exp_f32 v201, v201
    v_cvt_pk_bf16_f32 v54, v172, v173
    v_cvt_pk_bf16_f32 v55, v174, v175
    v_mfma_f32_32x32x16_bf16 a[208:223], a[4:7], a[8:11], a[208:223]
    v_add_f32 v38, v38, v198
    v_add_f32 v39, v39, v199
    v_fma_f32 v202, v202, s60, v30
    ds_write_b128 v22, v[52:55] offset:3072
    v_mfma_f32_32x32x16_bf16 a[224:239], a[4:7], a[12:15], a[224:239]
    buffer_load_dwordx4 v17, s[32:35], s61 offen offset:1024 nt lds
    v_fma_f32 v203, v203, s60, v30
    v_exp_f32 v202, v202
    v_mfma_f32_32x32x16_bf16 a[240:255], a[4:7], a[16:19], a[240:255]
    v_exp_f32 v203, v203
    v_add_f32 v38, v38, v200
    v_add_f32 v39, v39, v201
    v_fma_f32 v204, v204, s60, v30
    s_waitcnt lgkmcnt(1)
    v_mfma_f32_32x32x16_bf16 a[160:175], a[20:23], a[28:31], a[160:175]
    s_waitcnt vmcnt(20)
    ds_read_b64_tr_b16 a[40:41], v18 offset:12288
    ds_read_b64_tr_b16 a[42:43], v18 offset:13312
    ds_read_b64_tr_b16 a[44:45], v19 offset:12288
    ds_read_b64_tr_b16 a[46:47], v19 offset:13312
    ds_read_b128 a[48:51], v3 offset:30720
    v_fma_f32 v205, v205, s60, v30
    v_mfma_f32_32x32x16_bf16 a[176:191], a[20:23], a[32:35], a[176:191]
    s_add_u32 m0, s52, 10240
    s_mov_b32 s61, 172032
    buffer_load_dwordx4 v16, s[32:35], s61 offen offset:0 nt lds
    ds_read_b128 a[52:55], v3 offset:31744
    ds_read_b128 a[56:59], v3 offset:32768
    v_exp_f32 v204, v204
    v_exp_f32 v205, v205
    v_cvt_pk_bf16_f32 v48, v176, v177
    v_cvt_pk_bf16_f32 v49, v178, v179
    v_mfma_f32_32x32x16_bf16 a[192:207], a[20:23], a[36:39], a[192:207]
    v_add_f32 v38, v38, v202
    v_add_f32 v39, v39, v203
    v_fma_f32 v206, v206, s60, v30
    v_cvt_pk_bf16_f32 v50, v180, v181
    v_cvt_pk_bf16_f32 v51, v182, v183
    v_mfma_f32_32x32x16_bf16 a[208:223], a[24:27], a[28:31], a[208:223]
    v_fma_f32 v207, v207, s60, v30
    v_exp_f32 v206, v206
    ds_write_b128 v22, v[48:51] offset:1024
    v_mfma_f32_32x32x16_bf16 a[224:239], a[24:27], a[32:35], a[224:239]
    buffer_load_dwordx4 v17, s[32:35], s61 offen offset:1024 nt lds
    v_exp_f32 v207, v207
    v_add_f32 v38, v38, v204
    v_add_f32 v39, v39, v205
    v_mfma_f32_32x32x16_bf16 a[240:255], a[24:27], a[36:39], a[240:255]
    v_add_f32 v38, v38, v206
    v_add_f32 v39, v39, v207
    v_fma_f32 v208, v208, s60, v28
    v_fma_f32 v209, v209, s60, v28
    s_waitcnt lgkmcnt(1)
    v_mfma_f32_32x32x16_bf16 a[160:175], a[40:43], a[48:51], a[160:175]
    s_waitcnt vmcnt(20)
    ds_read_b64_tr_b16 a[60:61], v18 offset:14336
    ds_read_b64_tr_b16 a[62:63], v18 offset:15360
    ds_read_b64_tr_b16 a[64:65], v19 offset:14336
    ds_read_b64_tr_b16 a[66:67], v19 offset:15360
    ds_read_b128 a[68:71], v3 offset:33792
    v_exp_f32 v208, v208
    v_mfma_f32_32x32x16_bf16 a[176:191], a[40:43], a[52:55], a[176:191]
    s_add_u32 m0, s52, 12288
    s_mov_b32 s61, 229376
    buffer_load_dwordx4 v16, s[32:35], s61 offen offset:0 nt lds
    ds_read_b128 a[72:75], v3 offset:34816
    ds_read_b128 a[76:79], v3 offset:35840
    v_exp_f32 v209, v209
    v_fma_f32 v210, v210, s60, v28
    v_fma_f32 v211, v211, s60, v28
    v_cvt_pk_bf16_f32 v52, v184, v185
    v_cvt_pk_bf16_f32 v53, v186, v187
    v_mfma_f32_32x32x16_bf16 a[192:207], a[40:43], a[56:59], a[192:207]
    v_exp_f32 v210, v210
    v_cvt_pk_bf16_f32 v54, v188, v189
    v_cvt_pk_bf16_f32 v55, v190, v191
    v_mfma_f32_32x32x16_bf16 a[208:223], a[44:47], a[48:51], a[208:223]
    v_exp_f32 v211, v211
    v_add_f32 v34, v34, v208
    v_add_f32 v35, v35, v209
    ds_write_b128 v22, v[52:55] offset:4096
    v_mfma_f32_32x32x16_bf16 a[224:239], a[44:47], a[52:55], a[224:239]
    buffer_load_dwordx4 v17, s[32:35], s61 offen offset:1024 nt lds
    v_fma_f32 v212, v212, s60, v28
    v_fma_f32 v213, v213, s60, v28
    v_exp_f32 v212, v212
    v_mfma_f32_32x32x16_bf16 a[240:255], a[44:47], a[56:59], a[240:255]
    v_exp_f32 v213, v213
    v_add_f32 v34, v34, v210
    v_add_f32 v35, v35, v211
    v_fma_f32 v214, v214, s60, v28
    s_waitcnt lgkmcnt(1)
    v_mfma_f32_32x32x16_bf16 a[160:175], a[60:63], a[68:71], a[160:175]
    s_waitcnt vmcnt(20)
    ds_read_b64_tr_b16 a[0:1], v18 offset:0
    ds_read_b64_tr_b16 a[2:3], v18 offset:1024
    ds_read_b64_tr_b16 a[4:5], v19 offset:0
    ds_read_b64_tr_b16 a[6:7], v19 offset:1024
    ds_read_b128 a[8:11], v3 offset:36864
    v_fma_f32 v215, v215, s60, v28
    v_mfma_f32_32x32x16_bf16 a[176:191], a[60:63], a[72:75], a[176:191]
    s_add_u32 m0, s52, 14336
    s_mov_b32 s61, 237568
    buffer_load_dwordx4 v16, s[32:35], s61 offen offset:0 nt lds
    ds_read_b128 a[12:15], v3 offset:37888
    ds_read_b128 a[16:19], v3 offset:38912
    v_exp_f32 v214, v214
    v_cvt_pk_bf16_f32 v48, v192, v193
    v_cvt_pk_bf16_f32 v49, v194, v195
    v_mfma_f32_32x32x16_bf16 a[192:207], a[60:63], a[76:79], a[192:207]
    v_exp_f32 v215, v215
    v_add_f32 v34, v34, v212
    v_add_f32 v35, v35, v213
    v_cvt_pk_bf16_f32 v50, v196, v197
    v_cvt_pk_bf16_f32 v51, v198, v199
    v_mfma_f32_32x32x16_bf16 a[208:223], a[64:67], a[68:71], a[208:223]
    v_fma_f32 v216, v216, s60, v28
    v_fma_f32 v217, v217, s60, v28
    ds_write_b128 v22, v[48:51] offset:2048
    v_mfma_f32_32x32x16_bf16 a[224:239], a[64:67], a[72:75], a[224:239]
    buffer_load_dwordx4 v17, s[32:35], s61 offen offset:1024 nt lds
    v_exp_f32 v216, v216
    v_exp_f32 v217, v217
    v_add_f32 v34, v34, v214
    v_mfma_f32_32x32x16_bf16 a[240:255], a[64:67], a[76:79], a[240:255]
    v_add_f32 v35, v35, v215
    v_fma_f32 v218, v218, s60, v28
    v_fma_f32 v219, v219, s60, v28
    v_exp_f32 v218, v218
    s_waitcnt lgkmcnt(1)
    v_mfma_f32_32x32x16_bf16 a[160:175], a[0:3], a[8:11], a[160:175]
    s_waitcnt vmcnt(20)
    ds_read_b64_tr_b16 a[20:21], v18 offset:2048
    ds_read_b64_tr_b16 a[22:23], v18 offset:3072
    ds_read_b64_tr_b16 a[24:25], v19 offset:2048
    ds_read_b64_tr_b16 a[26:27], v19 offset:3072
    ds_read_b128 a[28:31], v3 offset:39936
    v_mfma_f32_32x32x16_bf16 a[176:191], a[0:3], a[12:15], a[176:191]
    s_add_u32 m0, s52, 0
    s_mov_b32 s61, 49152
    buffer_load_dwordx4 v16, s[32:35], s61 offen offset:0 nt lds
    ds_read_b128 a[32:35], v3 offset:40960
    ds_read_b128 a[36:39], v3 offset:41984
    v_exp_f32 v219, v219
    v_add_f32 v34, v34, v216
    v_add_f32 v35, v35, v217
    v_cvt_pk_bf16_f32 v52, v200, v201
    v_cvt_pk_bf16_f32 v53, v202, v203
    v_mfma_f32_32x32x16_bf16 a[192:207], a[0:3], a[16:19], a[192:207]
    v_fma_f32 v220, v220, s60, v28
    v_fma_f32 v221, v221, s60, v28
    v_exp_f32 v220, v220
    v_cvt_pk_bf16_f32 v54, v204, v205
    v_cvt_pk_bf16_f32 v55, v206, v207
    v_mfma_f32_32x32x16_bf16 a[208:223], a[4:7], a[8:11], a[208:223]
    v_exp_f32 v221, v221
    v_add_f32 v34, v34, v218
    ds_write_b128 v22, v[52:55] offset:5120
    v_mfma_f32_32x32x16_bf16 a[224:239], a[4:7], a[12:15], a[224:239]
    buffer_load_dwordx4 v17, s[32:35], s61 offen offset:1024 nt lds
    v_add_f32 v35, v35, v219
    v_fma_f32 v222, v222, s60, v28
    v_fma_f32 v223, v223, s60, v28
    v_mfma_f32_32x32x16_bf16 a[240:255], a[4:7], a[16:19], a[240:255]
    v_exp_f32 v222, v222
    v_exp_f32 v223, v223
    v_add_f32 v34, v34, v220
    s_waitcnt lgkmcnt(1)
    v_mfma_f32_32x32x16_bf16 a[160:175], a[20:23], a[28:31], a[160:175]
    s_waitcnt vmcnt(20)
    ds_read_b64_tr_b16 a[40:41], v18 offset:4096
    ds_read_b64_tr_b16 a[42:43], v18 offset:5120
    ds_read_b64_tr_b16 a[44:45], v19 offset:4096
    ds_read_b64_tr_b16 a[46:47], v19 offset:5120
    ds_read_b128 a[48:51], v3 offset:43008
    v_add_f32 v35, v35, v221
    v_mfma_f32_32x32x16_bf16 a[176:191], a[20:23], a[32:35], a[176:191]
    s_add_u32 m0, s52, 2048
    s_mov_b32 s61, 57344
    buffer_load_dwordx4 v16, s[32:35], s61 offen offset:0 nt lds
    ds_read_b128 a[52:55], v3 offset:44032
    ds_read_b128 a[56:59], v3 offset:45056
    v_fma_f32 v224, v224, s60, v29
    v_fma_f32 v225, v225, s60, v29
    v_exp_f32 v224, v224
    v_mfma_f32_32x32x16_bf16 a[192:207], a[20:23], a[36:39], a[192:207]
    v_exp_f32 v225, v225
    v_add_f32 v34, v34, v222
    v_add_f32 v35, v35, v223
    v_fma_f32 v226, v226, s60, v29
    v_mfma_f32_32x32x16_bf16 a[208:223], a[24:27], a[28:31], a[208:223]
    v_fma_f32 v227, v227, s60, v29
    v_exp_f32 v226, v226
    v_exp_f32 v227, v227
    v_mfma_f32_32x32x16_bf16 a[224:239], a[24:27], a[32:35], a[224:239]
    buffer_load_dwordx4 v17, s[32:35], s61 offen offset:1024 nt lds
    v_add_f32 v36, v36, v224
    v_add_f32 v37, v37, v225
    v_fma_f32 v228, v228, s60, v29
    v_fma_f32 v229, v229, s60, v29
    v_mfma_f32_32x32x16_bf16 a[240:255], a[24:27], a[36:39], a[240:255]
    v_exp_f32 v228, v228
    v_exp_f32 v229, v229
    v_add_f32 v36, v36, v226
    s_waitcnt lgkmcnt(0)
    v_mfma_f32_32x32x16_bf16 a[160:175], a[40:43], a[48:51], a[160:175]
    s_waitcnt vmcnt(20)
    ds_read_b64_tr_b16 a[60:61], v18 offset:6144
    ds_read_b64_tr_b16 a[62:63], v18 offset:7168
    ds_read_b64_tr_b16 a[64:65], v19 offset:6144
    ds_read_b64_tr_b16 a[66:67], v19 offset:7168
    ds_read_b128 a[68:71], v3 offset:46080
    v_mfma_f32_32x32x16_bf16 a[176:191], a[40:43], a[52:55], a[176:191]
    s_add_u32 m0, s52, 4096
    s_mov_b32 s61, 114688
    buffer_load_dwordx4 v16, s[32:35], s61 offen offset:0 nt lds
    ds_read_b128 a[72:75], v3 offset:47104
    ds_read_b128 a[76:79], v3 offset:48128
    v_mfma_f32_32x32x16_bf16 a[192:207], a[40:43], a[56:59], a[192:207]
    v_add_f32 v37, v37, v227
    v_fma_f32 v230, v230, s60, v29
    v_fma_f32 v231, v231, s60, v29
    v_exp_f32 v230, v230
    v_mfma_f32_32x32x16_bf16 a[208:223], a[44:47], a[48:51], a[208:223]
    v_exp_f32 v231, v231
    v_add_f32 v36, v36, v228
    v_add_f32 v37, v37, v229
    v_fma_f32 v232, v232, s60, v29
    v_mfma_f32_32x32x16_bf16 a[224:239], a[44:47], a[52:55], a[224:239]
    buffer_load_dwordx4 v17, s[32:35], s61 offen offset:1024 nt lds
    v_fma_f32 v233, v233, s60, v29
    v_exp_f32 v232, v232
    v_mfma_f32_32x32x16_bf16 a[240:255], a[44:47], a[56:59], a[240:255]
    v_exp_f32 v233, v233
    v_add_f32 v36, v36, v230
    v_add_f32 v37, v37, v231
    v_fma_f32 v234, v234, s60, v29
    s_waitcnt lgkmcnt(0)
    s_barrier
    v_mfma_f32_32x32x16_bf16 a[160:175], a[60:63], a[68:71], a[160:175]
    s_waitcnt vmcnt(20)
    ds_read_b64_tr_b16 a[0:1], v20 offset:0
    ds_read_b64_tr_b16 a[2:3], v20 offset:1024
    ds_read_b64_tr_b16 a[4:5], v21 offset:0
    ds_read_b64_tr_b16 a[6:7], v21 offset:1024
    ds_read_b128 a[8:11], v3 offset:0
    v_mfma_f32_32x32x16_bf16 a[176:191], a[60:63], a[72:75], a[176:191]
    s_add_u32 m0, s52, 6144
    s_mov_b32 s61, 122880
    buffer_load_dwordx4 v16, s[32:35], s61 offen offset:0 nt lds
    ds_read_b128 a[12:15], v3 offset:1024
    ds_read_b128 a[16:19], v3 offset:2048
    v_fma_f32 v235, v235, s60, v29
    v_mfma_f32_32x32x16_bf16 a[192:207], a[60:63], a[76:79], a[192:207]
    v_exp_f32 v234, v234
    v_exp_f32 v235, v235
    v_add_f32 v36, v36, v232
    v_mfma_f32_32x32x16_bf16 a[208:223], a[64:67], a[68:71], a[208:223]
    v_add_f32 v37, v37, v233
    v_fma_f32 v236, v236, s60, v29
    v_fma_f32 v237, v237, s60, v29
    v_exp_f32 v236, v236
    v_mfma_f32_32x32x16_bf16 a[224:239], a[64:67], a[72:75], a[224:239]
    buffer_load_dwordx4 v17, s[32:35], s61 offen offset:1024 nt lds
    v_exp_f32 v237, v237
    v_add_f32 v36, v36, v234
    v_add_f32 v37, v37, v235
    v_mfma_f32_32x32x16_bf16 a[240:255], a[64:67], a[76:79], a[240:255]
    v_cvt_pk_bf16_f32 v48, v208, v209
    v_cvt_pk_bf16_f32 v49, v210, v211
    v_fma_f32 v238, v238, s60, v29
    v_fma_f32 v239, v239, s60, v29
    v_cvt_pk_bf16_f32 v50, v212, v213
    s_waitcnt lgkmcnt(0)
    v_mfma_f32_32x32x16_bf16 a[160:175], a[0:3], a[8:11], a[160:175]
    s_waitcnt vmcnt(20)
    ds_read_b64_tr_b16 a[20:21], v20 offset:2048
    ds_read_b64_tr_b16 a[22:23], v20 offset:3072
    ds_read_b64_tr_b16 a[24:25], v21 offset:2048
    ds_read_b64_tr_b16 a[26:27], v21 offset:3072
    ds_read_b128 a[28:31], v3 offset:3072
    v_cvt_pk_bf16_f32 v51, v214, v215
    v_mfma_f32_32x32x16_bf16 a[176:191], a[0:3], a[12:15], a[176:191]
    s_add_u32 m0, s53, 0
    s_mov_b32 s61, 180224
    buffer_load_dwordx4 v16, s[32:35], s61 offen offset:0 nt lds
    ds_read_b128 a[32:35], v3 offset:4096
    ds_read_b128 a[36:39], v3 offset:5120
    v_exp_f32 v238, v238
    v_exp_f32 v239, v239
    ds_write_b128 v22, v[48:51] offset:24576
    v_mfma_f32_32x32x16_bf16 a[192:207], a[0:3], a[16:19], a[192:207]
    v_add_f32 v36, v36, v236
    v_add_f32 v37, v37, v237
    v_fma_f32 v240, v240, s60, v30
    v_fma_f32 v241, v241, s60, v30
    v_mfma_f32_32x32x16_bf16 a[208:223], a[4:7], a[8:11], a[208:223]
    v_exp_f32 v240, v240
    v_exp_f32 v241, v241
    v_add_f32 v36, v36, v238
    v_mfma_f32_32x32x16_bf16 a[224:239], a[4:7], a[12:15], a[224:239]
    buffer_load_dwordx4 v17, s[32:35], s61 offen offset:1024 nt lds
    v_add_f32 v37, v37, v239
    v_fma_f32 v242, v242, s60, v30
    v_fma_f32 v243, v243, s60, v30
    v_mfma_f32_32x32x16_bf16 a[240:255], a[4:7], a[16:19], a[240:255]
    v_cvt_pk_bf16_f32 v52, v216, v217
    v_cvt_pk_bf16_f32 v53, v218, v219
    v_exp_f32 v242, v242
    v_cvt_pk_bf16_f32 v54, v220, v221
    s_waitcnt lgkmcnt(1)
    v_mfma_f32_32x32x16_bf16 a[160:175], a[20:23], a[28:31], a[160:175]
    s_waitcnt vmcnt(20)
    ds_read_b64_tr_b16 a[40:41], v20 offset:4096
    ds_read_b64_tr_b16 a[42:43], v20 offset:5120
    ds_read_b64_tr_b16 a[44:45], v21 offset:4096
    ds_read_b64_tr_b16 a[46:47], v21 offset:5120
    ds_read_b128 a[48:51], v3 offset:6144
    v_exp_f32 v243, v243
    v_cvt_pk_bf16_f32 v55, v222, v223
    v_mfma_f32_32x32x16_bf16 a[176:191], a[20:23], a[32:35], a[176:191]
    s_add_u32 m0, s53, 2048
    s_mov_b32 s61, 188416
    buffer_load_dwordx4 v16, s[32:35], s61 offen offset:0 nt lds
    ds_read_b128 a[52:55], v3 offset:7168
    ds_read_b128 a[56:59], v3 offset:8192
    v_add_f32 v38, v38, v240
    v_add_f32 v39, v39, v241
    v_fma_f32 v244, v244, s60, v30
    ds_write_b128 v22, v[52:55] offset:27648
    v_mfma_f32_32x32x16_bf16 a[192:207], a[20:23], a[36:39], a[192:207]
    v_fma_f32 v245, v245, s60, v30
    v_exp_f32 v244, v244
    v_exp_f32 v245, v245
    v_mfma_f32_32x32x16_bf16 a[208:223], a[24:27], a[28:31], a[208:223]
    v_add_f32 v38, v38, v242
    v_add_f32 v39, v39, v243
    v_fma_f32 v246, v246, s60, v30
    v_fma_f32 v247, v247, s60, v30
    v_mfma_f32_32x32x16_bf16 a[224:239], a[24:27], a[32:35], a[224:239]
    buffer_load_dwordx4 v17, s[32:35], s61 offen offset:1024 nt lds
    v_exp_f32 v246, v246
    v_exp_f32 v247, v247
    v_mfma_f32_32x32x16_bf16 a[240:255], a[24:27], a[36:39], a[240:255]
    v_cvt_pk_bf16_f32 v48, v224, v225
    v_cvt_pk_bf16_f32 v49, v226, v227
    v_add_f32 v38, v38, v244
    v_add_f32 v39, v39, v245
    v_fma_f32 v248, v248, s60, v30
    s_waitcnt lgkmcnt(1)
    v_mfma_f32_32x32x16_bf16 a[160:175], a[40:43], a[48:51], a[160:175]
    s_waitcnt vmcnt(20)
    ds_read_b64_tr_b16 a[60:61], v20 offset:6144
    ds_read_b64_tr_b16 a[62:63], v20 offset:7168
    ds_read_b64_tr_b16 a[64:65], v21 offset:6144
    ds_read_b64_tr_b16 a[66:67], v21 offset:7168
    ds_read_b128 a[68:71], v3 offset:9216
    v_cvt_pk_bf16_f32 v50, v228, v229
    v_cvt_pk_bf16_f32 v51, v230, v231
    v_mfma_f32_32x32x16_bf16 a[176:191], a[40:43], a[52:55], a[176:191]
    s_add_u32 m0, s53, 4096
    s_mov_b32 s61, 245760
    buffer_load_dwordx4 v16, s[32:35], s61 offen offset:0 nt lds
    ds_read_b128 a[72:75], v3 offset:10240
    ds_read_b128 a[76:79], v3 offset:11264
    v_fma_f32 v249, v249, s60, v30
    v_exp_f32 v248, v248
    ds_write_b128 v22, v[48:51] offset:25600
    v_mfma_f32_32x32x16_bf16 a[192:207], a[40:43], a[56:59], a[192:207]
    v_exp_f32 v249, v249
    v_add_f32 v38, v38, v246
    v_add_f32 v39, v39, v247
    v_fma_f32 v250, v250, s60, v30
    v_mfma_f32_32x32x16_bf16 a[208:223], a[44:47], a[48:51], a[208:223]
    v_fma_f32 v251, v251, s60, v30
    v_exp_f32 v250, v250
    v_exp_f32 v251, v251
    v_mfma_f32_32x32x16_bf16 a[224:239], a[44:47], a[52:55], a[224:239]
    buffer_load_dwordx4 v17, s[32:35], s61 offen offset:1024 nt lds
    v_add_f32 v38, v38, v248
    v_add_f32 v39, v39, v249
    v_fma_f32 v252, v252, s60, v30
    v_fma_f32 v253, v253, s60, v30
    v_mfma_f32_32x32x16_bf16 a[240:255], a[44:47], a[56:59], a[240:255]
    v_cvt_pk_bf16_f32 v52, v232, v233
    v_cvt_pk_bf16_f32 v53, v234, v235
    v_exp_f32 v252, v252
    v_cvt_pk_bf16_f32 v54, v236, v237
    s_waitcnt lgkmcnt(1)
    v_mfma_f32_32x32x16_bf16 a[160:175], a[60:63], a[68:71], a[160:175]
    s_waitcnt vmcnt(20)
    ds_read_b64_tr_b16 a[0:1], v18 offset:8192
    ds_read_b64_tr_b16 a[2:3], v18 offset:9216
    ds_read_b64_tr_b16 a[4:5], v19 offset:8192
    ds_read_b64_tr_b16 a[6:7], v19 offset:9216
    ds_read_b128 a[8:11], v3 offset:12288
    v_cvt_pk_bf16_f32 v55, v238, v239
    v_mfma_f32_32x32x16_bf16 a[176:191], a[60:63], a[72:75], a[176:191]
    s_add_u32 m0, s53, 6144
    s_mov_b32 s61, 253952
    buffer_load_dwordx4 v16, s[32:35], s61 offen offset:0 nt lds
    ds_read_b128 a[12:15], v3 offset:13312
    ds_read_b128 a[16:19], v3 offset:14336
    v_exp_f32 v253, v253
    v_add_f32 v38, v38, v250
    v_add_f32 v39, v39, v251
    ds_write_b128 v22, v[52:55] offset:28672
    v_mfma_f32_32x32x16_bf16 a[192:207], a[60:63], a[76:79], a[192:207]
    v_fma_f32 v254, v254, s60, v30
    v_fma_f32 v255, v255, s60, v30
    v_exp_f32 v254, v254
    v_mfma_f32_32x32x16_bf16 a[208:223], a[64:67], a[68:71], a[208:223]
    v_exp_f32 v255, v255
    v_add_f32 v38, v38, v252
    v_add_f32 v39, v39, v253
    v_add_f32 v38, v38, v254
    v_mfma_f32_32x32x16_bf16 a[224:239], a[64:67], a[72:75], a[224:239]
    buffer_load_dwordx4 v17, s[32:35], s61 offen offset:1024 nt lds
    v_add_f32 v39, v39, v255
    v_mfma_f32_32x32x16_bf16 a[240:255], a[64:67], a[76:79], a[240:255]
    v_cvt_pk_bf16_f32 v48, v240, v241
    v_cvt_pk_bf16_f32 v49, v242, v243
    v_cvt_pk_bf16_f32 v50, v244, v245
    v_cvt_pk_bf16_f32 v51, v246, v247
    v_add_f32 v34, v34, v35
    s_waitcnt lgkmcnt(1)
    v_mfma_f32_32x32x16_bf16 a[160:175], a[0:3], a[8:11], a[160:175]
    s_waitcnt vmcnt(20)
    ds_read_b64_tr_b16 a[20:21], v18 offset:10240
    ds_read_b64_tr_b16 a[22:23], v18 offset:11264
    ds_read_b64_tr_b16 a[24:25], v19 offset:10240
    ds_read_b64_tr_b16 a[26:27], v19 offset:11264
    ds_read_b128 a[28:31], v3 offset:15360
    v_mfma_f32_32x32x16_bf16 a[176:191], a[0:3], a[12:15], a[176:191]
    ds_read_b128 a[32:35], v3 offset:16384
    ds_read_b128 a[36:39], v3 offset:17408
    ds_write_b128 v22, v[48:51] offset:26624
    v_add_f32 v36, v36, v37
    v_mfma_f32_32x32x16_bf16 a[192:207], a[0:3], a[16:19], a[192:207]
    v_add_f32 v38, v38, v39
    v_mfma_f32_32x32x16_bf16 a[208:223], a[4:7], a[8:11], a[208:223]
    v_mfma_f32_32x32x16_bf16 a[224:239], a[4:7], a[12:15], a[224:239]
    v_mfma_f32_32x32x16_bf16 a[240:255], a[4:7], a[16:19], a[240:255]
    v_cvt_pk_bf16_f32 v52, v248, v249
    v_cvt_pk_bf16_f32 v53, v250, v251
    v_cvt_pk_bf16_f32 v54, v252, v253
    v_cvt_pk_bf16_f32 v55, v254, v255
    s_waitcnt lgkmcnt(1)
    v_mfma_f32_32x32x16_bf16 a[160:175], a[20:23], a[28:31], a[160:175]
    s_add_u32 m0, s52, 8192
    s_add_u32 s61, s55, s62
    buffer_load_dwordx4 v12, s[36:39], s61 offen offset:0  lds
    s_waitcnt vmcnt(19)
    ds_read_b64_tr_b16 a[40:41], v18 offset:12288
    ds_read_b64_tr_b16 a[42:43], v18 offset:13312
    ds_read_b64_tr_b16 a[44:45], v19 offset:12288
    ds_read_b64_tr_b16 a[46:47], v19 offset:13312
    ds_read_b128 a[48:51], v3 offset:18432
    v_mfma_f32_32x32x16_bf16 a[176:191], a[20:23], a[32:35], a[176:191]
    ds_read_b128 a[52:55], v3 offset:19456
    ds_read_b128 a[56:59], v3 offset:20480
    ds_write_b128 v22, v[52:55] offset:29696
    v_mfma_f32_32x32x16_bf16 a[192:207], a[20:23], a[36:39], a[192:207]
    buffer_load_dwordx4 v13, s[36:39], s61 offen offset:1024  lds
    v_mfma_f32_32x32x16_bf16 a[208:223], a[24:27], a[28:31], a[208:223]
    v_mfma_f32_32x32x16_bf16 a[224:239], a[24:27], a[32:35], a[224:239]
    buffer_load_dwordx4 v14, s[36:39], s61 offen offset:2048  lds
    v_mfma_f32_32x32x16_bf16 a[240:255], a[24:27], a[36:39], a[240:255]
    s_waitcnt lgkmcnt(1)
    v_mfma_f32_32x32x16_bf16 a[160:175], a[40:43], a[48:51], a[160:175]
    buffer_load_dwordx4 v15, s[36:39], s61 offen offset:3072  lds
    s_waitcnt vmcnt(20)
    ds_read_b64_tr_b16 a[60:61], v18 offset:14336
    ds_read_b64_tr_b16 a[62:63], v18 offset:15360
    ds_read_b64_tr_b16 a[64:65], v19 offset:14336
    ds_read_b64_tr_b16 a[66:67], v19 offset:15360
    ds_read_b128 a[68:71], v3 offset:21504
    v_mfma_f32_32x32x16_bf16 a[176:191], a[40:43], a[52:55], a[176:191]
    ds_read_b128 a[72:75], v3 offset:22528
    ds_read_b128 a[76:79], v3 offset:23552
    v_mfma_f32_32x32x16_bf16 a[192:207], a[40:43], a[56:59], a[192:207]
    v_mfma_f32_32x32x16_bf16 a[208:223], a[44:47], a[48:51], a[208:223]
    v_mov_b32 v56, v34
    v_mov_b32 v57, v36
    v_mov_b32 v58, v38
    s_nop 1
    v_permlane32_swap_b32 v34, v56
    v_permlane32_swap_b32 v36, v57
    v_permlane32_swap_b32 v38, v58
    s_nop 0
    v_add_f32 v34, v34, v56
    v_add_f32 v36, v36, v57
    v_add_f32 v38, v38, v58
    ds_write_b32 v24, v34 offset:1536
    v_mfma_f32_32x32x16_bf16 a[224:239], a[44:47], a[52:55], a[224:239]
    ds_write_b32 v24, v36 offset:2048
    ds_write_b32 v24, v38 offset:2560
    v_mfma_f32_32x32x16_bf16 a[240:255], a[44:47], a[56:59], a[240:255]
    s_waitcnt lgkmcnt(0)
    s_barrier
    v_mfma_f32_32x32x16_bf16 a[160:175], a[60:63], a[68:71], a[160:175]
    s_add_u32 m0, s52, 12288
    s_add_u32 s61, s55, s62
    s_add_u32 s61, s61, 28672
    buffer_load_dwordx4 v12, s[36:39], s61 offen offset:0  lds
    s_waitcnt vmcnt(19)
    ds_read_b64_tr_b16 a[0:1], v18 offset:0
    ds_read_b64_tr_b16 a[2:3], v18 offset:1024
    ds_read_b64_tr_b16 a[4:5], v19 offset:0
    ds_read_b64_tr_b16 a[6:7], v19 offset:1024
    ds_read_b128 a[8:11], v3 offset:24576
    v_mfma_f32_32x32x16_bf16 a[176:191], a[60:63], a[72:75], a[176:191]
    ds_read_b128 a[12:15], v3 offset:25600
    ds_read_b128 a[16:19], v3 offset:26624
    ds_read_b128 v[48:51], v23 offset:1536
    ds_read_b128 v[52:55], v23 offset:2048
    ds_read_b128 v[56:59], v23 offset:2560
    v_mfma_f32_32x32x16_bf16 a[192:207], a[60:63], a[76:79], a[192:207]
    buffer_load_dwordx4 v13, s[36:39], s61 offen offset:1024  lds
    v_mfma_f32_32x32x16_bf16 a[208:223], a[64:67], a[68:71], a[208:223]
    v_mfma_f32_32x32x16_bf16 a[224:239], a[64:67], a[72:75], a[224:239]
    buffer_load_dwordx4 v14, s[36:39], s61 offen offset:2048  lds
    v_mfma_f32_32x32x16_bf16 a[240:255], a[64:67], a[76:79], a[240:255]
    s_waitcnt lgkmcnt(3)
    v_mfma_f32_32x32x16_bf16 a[160:175], a[0:3], a[8:11], a[160:175]
    buffer_load_dwordx4 v15, s[36:39], s61 offen offset:3072  lds
    s_waitcnt vmcnt(20)
    ds_read_b64_tr_b16 a[20:21], v18 offset:2048
    ds_read_b64_tr_b16 a[22:23], v18 offset:3072
    ds_read_b64_tr_b16 a[24:25], v19 offset:2048
    ds_read_b64_tr_b16 a[26:27], v19 offset:3072
    ds_read_b128 a[28:31], v3 offset:27648
    v_mfma_f32_32x32x16_bf16 a[176:191], a[0:3], a[12:15], a[176:191]
    ds_read_b128 a[32:35], v3 offset:28672
    ds_read_b128 a[36:39], v3 offset:29696
    v_mfma_f32_32x32x16_bf16 a[192:207], a[0:3], a[16:19], a[192:207]
    v_mfma_f32_32x32x16_bf16 a[208:223], a[4:7], a[8:11], a[208:223]
    v_mfma_f32_32x32x16_bf16 a[224:239], a[4:7], a[12:15], a[224:239]
    v_mfma_f32_32x32x16_bf16 a[240:255], a[4:7], a[16:19], a[240:255]
    s_waitcnt lgkmcnt(0)
    v_mfma_f32_32x32x16_bf16 a[160:175], a[20:23], a[28:31], a[160:175]
    s_add_u32 m0, s52, 0
    s_add_u32 s61, s55, s63
    buffer_load_dwordx4 v12, s[36:39], s61 offen offset:0  lds
    s_waitcnt vmcnt(19)
    ds_read_b64_tr_b16 a[40:41], v18 offset:4096
    ds_read_b64_tr_b16 a[42:43], v18 offset:5120
    ds_read_b64_tr_b16 a[44:45], v19 offset:4096
    ds_read_b64_tr_b16 a[46:47], v19 offset:5120
    ds_read_b128 a[48:51], v3 offset:30720
    v_mfma_f32_32x32x16_bf16 a[176:191], a[20:23], a[32:35], a[176:191]
    ds_read_b128 a[52:55], v3 offset:31744
    ds_read_b128 a[56:59], v3 offset:32768
    v_add_f32 v48, v48, v49
    v_add_f32 v50, v50, v51
    v_add_f32 v48, v48, v50
    v_mfma_f32_32x32x16_bf16 a[192:207], a[20:23], a[36:39], a[192:207]
    buffer_load_dwordx4 v13, s[36:39], s61 offen offset:1024  lds
    v_rcp_f32 v40, v48
    v_add_f32 v52, v52, v53
    v_add_f32 v54, v54, v55
    v_mfma_f32_32x32x16_bf16 a[208:223], a[24:27], a[28:31], a[208:223]
    v_add_f32 v52, v52, v54
    v_rcp_f32 v41, v52
    v_add_f32 v56, v56, v57
    v_add_f32 v58, v58, v59
    v_mfma_f32_32x32x16_bf16 a[224:239], a[24:27], a[32:35], a[224:239]
    buffer_load_dwordx4 v14, s[36:39], s61 offen offset:2048  lds
    v_add_f32 v56, v56, v58
    v_rcp_f32 v42, v56
    v_bfe_u32 v60, v1, 4, 1
    v_mfma_f32_32x32x16_bf16 a[240:255], a[24:27], a[36:39], a[240:255]
    v_lshlrev_b32 v60, 10, v60
    v_lshrrev_b32 v61, 5, v1
    v_lshl_add_u32 v60, v61, 8, v60
    v_and_b32 v61, 15, v1
    v_lshl_add_u32 v60, v61, 4, v60
    s_waitcnt lgkmcnt(0)
    v_mfma_f32_32x32x16_bf16 a[160:175], a[40:43], a[48:51], a[160:175]
    buffer_load_dwordx4 v15, s[36:39], s61 offen offset:3072  lds
    s_waitcnt vmcnt(20)
    ds_read_b64_tr_b16 a[60:61], v18 offset:6144
    ds_read_b64_tr_b16 a[62:63], v18 offset:7168
    ds_read_b64_tr_b16 a[64:65], v19 offset:6144
    ds_read_b64_tr_b16 a[66:67], v19 offset:7168
    ds_read_b128 a[68:71], v3 offset:33792
    v_mfma_f32_32x32x16_bf16 a[176:191], a[40:43], a[52:55], a[176:191]
    ds_read_b128 a[72:75], v3 offset:34816
    ds_read_b128 a[76:79], v3 offset:35840
    s_mul_i32 s56, s48, 12288
    s_add_u32 s56, s56, 36864
    v_add_u32 v22, s56, v60
    v_mfma_f32_32x32x16_bf16 a[192:207], a[40:43], a[56:59], a[192:207]
    v_mfma_f32_32x32x16_bf16 a[208:223], a[44:47], a[48:51], a[208:223]
    v_mfma_f32_32x32x16_bf16 a[224:239], a[44:47], a[52:55], a[224:239]
    v_mfma_f32_32x32x16_bf16 a[240:255], a[44:47], a[56:59], a[240:255]
    s_waitcnt lgkmcnt(0)
    v_mfma_f32_32x32x16_bf16 a[160:175], a[60:63], a[68:71], a[160:175]
    s_add_u32 m0, s52, 4096
    s_add_u32 s61, s55, s63
    s_add_u32 s61, s61, 28672
    buffer_load_dwordx4 v12, s[36:39], s61 offen offset:0  lds
    s_waitcnt vmcnt(19)
    ds_read_b64_tr_b16 a[0:1], v20 offset:0
    ds_read_b64_tr_b16 a[2:3], v20 offset:1024
    ds_read_b64_tr_b16 a[4:5], v21 offset:0
    ds_read_b64_tr_b16 a[6:7], v21 offset:1024
    ds_read_b128 a[8:11], v3 offset:36864
    v_mfma_f32_32x32x16_bf16 a[176:191], a[60:63], a[72:75], a[176:191]
    ds_read_b128 a[12:15], v3 offset:37888
    ds_read_b128 a[16:19], v3 offset:38912
    v_mfma_f32_32x32x16_bf16 a[192:207], a[60:63], a[76:79], a[192:207]
    buffer_load_dwordx4 v13, s[36:39], s61 offen offset:1024  lds
    s_waitcnt vmcnt(18)
    ds_read_b64_tr_b16 a[20:21], v20 offset:2048
    ds_read_b64_tr_b16 a[22:23], v20 offset:3072
    ds_read_b64_tr_b16 a[24:25], v21 offset:2048
    ds_read_b64_tr_b16 a[26:27], v21 offset:3072
    ds_read_b128 a[28:31], v3 offset:39936
    v_mfma_f32_32x32x16_bf16 a[208:223], a[64:67], a[68:71], a[208:223]
    ds_read_b128 a[32:35], v3 offset:40960
    ds_read_b128 a[36:39], v3 offset:41984
    v_mfma_f32_32x32x16_bf16 a[224:239], a[64:67], a[72:75], a[224:239]
    buffer_load_dwordx4 v14, s[36:39], s61 offen offset:2048  lds
    s_waitcnt vmcnt(17)
    ds_read_b64_tr_b16 a[40:41], v20 offset:4096
    ds_read_b64_tr_b16 a[42:43], v20 offset:5120
    ds_read_b64_tr_b16 a[44:45], v21 offset:4096
    ds_read_b64_tr_b16 a[46:47], v21 offset:5120
    ds_read_b128 a[48:51], v3 offset:43008
    v_mfma_f32_32x32x16_bf16 a[240:255], a[64:67], a[76:79], a[240:255]
    ds_read_b128 a[52:55], v3 offset:44032
    ds_read_b128 a[56:59], v3 offset:45056
    s_waitcnt lgkmcnt(14)
    v_mfma_f32_32x32x16_bf16 a[160:175], a[0:3], a[8:11], a[160:175]
    buffer_load_dwordx4 v15, s[36:39], s61 offen offset:3072  lds
    s_waitcnt vmcnt(16)
    ds_read_b64_tr_b16 a[60:61], v20 offset:6144
    ds_read_b64_tr_b16 a[62:63], v20 offset:7168
    ds_read_b64_tr_b16 a[64:65], v21 offset:6144
    ds_read_b64_tr_b16 a[66:67], v21 offset:7168
    ds_read_b128 a[68:71], v3 offset:46080
    v_mfma_f32_32x32x16_bf16 a[208:223], a[4:7], a[8:11], a[208:223]
    ds_read_b128 a[72:75], v3 offset:47104
    ds_read_b128 a[76:79], v3 offset:48128
    s_waitcnt lgkmcnt(14)
    v_mfma_f32_32x32x16_bf16 a[160:175], a[20:23], a[28:31], a[160:175]
    v_mfma_f32_32x32x16_bf16 a[208:223], a[24:27], a[28:31], a[208:223]
    s_waitcnt lgkmcnt(7)
    v_mfma_f32_32x32x16_bf16 a[160:175], a[40:43], a[48:51], a[160:175]
    v_mfma_f32_32x32x16_bf16 a[208:223], a[44:47], a[48:51], a[208:223]
    s_waitcnt lgkmcnt(0)
    s_barrier
    v_mfma_f32_32x32x16_bf16 a[160:175], a[60:63], a[68:71], a[160:175]
    v_mfma_f32_32x32x16_bf16 a[208:223], a[64:67], a[68:71], a[208:223]
    v_mfma_f32_32x32x16_bf16 a[176:191], a[0:3], a[12:15], a[176:191]
    s_add_u32 m0, s53, 0
    s_add_u32 s61, s55, s64
    buffer_load_dwordx4 v12, s[36:39], s61 offen offset:0  lds
    v_mfma_f32_32x32x16_bf16 a[224:239], a[4:7], a[12:15], a[224:239]
    v_accvgpr_read_b32 v64, a160
    v_accvgpr_read_b32 v65, a161
    v_accvgpr_read_b32 v66, a162
    v_accvgpr_read_b32 v67, a163
    v_accvgpr_read_b32 v68, a164
    v_accvgpr_read_b32 v69, a165
    v_accvgpr_read_b32 v70, a166
    v_accvgpr_read_b32 v71, a167
    v_accvgpr_read_b32 v72, a168
    v_accvgpr_read_b32 v73, a169
    v_accvgpr_read_b32 v74, a170
    v_mfma_f32_32x32x16_bf16 a[176:191], a[20:23], a[32:35], a[176:191]
    buffer_load_dwordx4 v13, s[36:39], s61 offen offset:1024  lds
    v_accvgpr_read_b32 v75, a171
    v_accvgpr_read_b32 v76, a172
    v_accvgpr_read_b32 v77, a173
    v_accvgpr_read_b32 v78, a174
    v_accvgpr_read_b32 v79, a175
    v_mul_f32 v64, v64, v40
    v_mul_f32 v65, v65, v40
    v_mul_f32 v66, v66, v40
    v_mul_f32 v67, v67, v40
    v_mul_f32 v68, v68, v40
    v_mul_f32 v69, v69, v40
    v_mfma_f32_32x32x16_bf16 a[224:239], a[24:27], a[32:35], a[224:239]
    v_mul_f32 v70, v70, v40
    v_mul_f32 v71, v71, v40
    v_mul_f32 v72, v72, v40
    v_mul_f32 v73, v73, v40
    v_mul_f32 v74, v74, v40
    v_mul_f32 v75, v75, v40
    v_mul_f32 v76, v76, v40
    v_mul_f32 v77, v77, v40
    v_mul_f32 v78, v78, v40
    v_mul_f32 v79, v79, v40
    v_cvt_pk_bf16_f32 v80, v64, v65
    v_mfma_f32_32x32x16_bf16 a[176:191], a[40:43], a[52:55], a[176:191]
    buffer_load_dwordx4 v14, s[36:39], s61 offen offset:2048  lds
    v_cvt_pk_bf16_f32 v81, v66, v67
    v_cvt_pk_bf16_f32 v82, v68, v69
    v_cvt_pk_bf16_f32 v83, v70, v71
    ds_write_b128 v22, v[80:83] offset:0
    v_cvt_pk_bf16_f32 v84, v72, v73
    v_cvt_pk_bf16_f32 v85, v74, v75
    v_cvt_pk_bf16_f32 v86, v76, v77
    v_cvt_pk_bf16_f32 v87, v78, v79
    ds_write_b128 v22, v[84:87] offset:512
    v_mfma_f32_32x32x16_bf16 a[224:239], a[44:47], a[52:55], a[224:239]
    v_accvgpr_read_b32 v136, a208
    v_accvgpr_read_b32 v137, a209
    v_accvgpr_read_b32 v138, a210
    v_accvgpr_read_b32 v139, a211
    v_accvgpr_read_b32 v140, a212
    v_accvgpr_read_b32 v141, a213
    v_accvgpr_read_b32 v142, a214
    v_accvgpr_read_b32 v143, a215
    v_accvgpr_read_b32 v144, a216
    v_accvgpr_read_b32 v145, a217
    v_accvgpr_read_b32 v146, a218
    v_mfma_f32_32x32x16_bf16 a[176:191], a[60:63], a[72:75], a[176:191]
    buffer_load_dwordx4 v15, s[36:39], s61 offen offset:3072  lds
    v_accvgpr_read_b32 v147, a219
    v_accvgpr_read_b32 v148, a220
    v_accvgpr_read_b32 v149, a221
    v_accvgpr_read_b32 v150, a222
    v_accvgpr_read_b32 v151, a223
    v_mul_f32 v136, v136, v40
    v_mul_f32 v137, v137, v40
    v_mul_f32 v138, v138, v40
    v_mul_f32 v139, v139, v40
    v_mul_f32 v140, v140, v40
    v_mul_f32 v141, v141, v40
    v_mfma_f32_32x32x16_bf16 a[224:239], a[64:67], a[72:75], a[224:239]
    v_mul_f32 v142, v142, v40
    v_mul_f32 v143, v143, v40
    v_mul_f32 v144, v144, v40
    v_mul_f32 v145, v145, v40
    v_mul_f32 v146, v146, v40
    v_mul_f32 v147, v147, v40
    v_mul_f32 v148, v148, v40
    v_mul_f32 v149, v149, v40
    v_mul_f32 v150, v150, v40
    v_mul_f32 v151, v151, v40
    v_cvt_pk_bf16_f32 v152, v136, v137
    v_mfma_f32_32x32x16_bf16 a[192:207], a[0:3], a[16:19], a[192:207]
    s_add_u32 m0, s53, 4096
    s_add_u32 s61, s55, s64
    s_add_u32 s61, s61, 28672
    buffer_load_dwordx4 v12, s[36:39], s61 offen offset:0  lds
    v_cvt_pk_bf16_f32 v153, v138, v139
    v_cvt_pk_bf16_f32 v154, v140, v141
    v_cvt_pk_bf16_f32 v155, v142, v143
    ds_write_b128 v22, v[152:155] offset:6144
    v_cvt_pk_bf16_f32 v156, v144, v145
    v_cvt_pk_bf16_f32 v157, v146, v147
    v_cvt_pk_bf16_f32 v158, v148, v149
    v_cvt_pk_bf16_f32 v159, v150, v151
    ds_write_b128 v22, v[156:159] offset:6656
    v_mfma_f32_32x32x16_bf16 a[240:255], a[4:7], a[16:19], a[240:255]
    v_accvgpr_read_b32 v88, a176
    v_accvgpr_read_b32 v89, a177
    v_accvgpr_read_b32 v90, a178
    v_accvgpr_read_b32 v91, a179
    v_accvgpr_read_b32 v92, a180
    v_accvgpr_read_b32 v93, a181
    v_accvgpr_read_b32 v94, a182
    v_accvgpr_read_b32 v95, a183
    v_accvgpr_read_b32 v96, a184
    v_accvgpr_read_b32 v97, a185
    v_accvgpr_read_b32 v98, a186
    v_mfma_f32_32x32x16_bf16 a[192:207], a[20:23], a[36:39], a[192:207]
    buffer_load_dwordx4 v13, s[36:39], s61 offen offset:1024  lds
    v_accvgpr_read_b32 v99, a187
    v_accvgpr_read_b32 v100, a188
    v_accvgpr_read_b32 v101, a189
    v_accvgpr_read_b32 v102, a190
    v_accvgpr_read_b32 v103, a191
    v_mul_f32 v88, v88, v41
    v_mul_f32 v89, v89, v41
    v_mul_f32 v90, v90, v41
    v_mul_f32 v91, v91, v41
    v_mul_f32 v92, v92, v41
    v_mul_f32 v93, v93, v41
    v_mfma_f32_32x32x16_bf16 a[240:255], a[24:27], a[36:39], a[240:255]
    v_mul_f32 v94, v94, v41
    v_mul_f32 v95, v95, v41
    v_mul_f32 v96, v96, v41
    v_mul_f32 v97, v97, v41
    v_mul_f32 v98, v98, v41
    v_mul_f32 v99, v99, v41
    v_mul_f32 v100, v100, v41
    v_mul_f32 v101, v101, v41
    v_mul_f32 v102, v102, v41
    v_mul_f32 v103, v103, v41
    v_cvt_pk_bf16_f32 v104, v88, v89
    v_mfma_f32_32x32x16_bf16 a[192:207], a[40:43], a[56:59], a[192:207]
    buffer_load_dwordx4 v14, s[36:39], s61 offen offset:2048  lds
    v_cvt_pk_bf16_f32 v105, v90, v91
    v_cvt_pk_bf16_f32 v106, v92, v93
    v_cvt_pk_bf16_f32 v107, v94, v95
    ds_write_b128 v22, v[104:107] offset:2048
    v_cvt_pk_bf16_f32 v108, v96, v97
    v_cvt_pk_bf16_f32 v109, v98, v99
    v_cvt_pk_bf16_f32 v110, v100, v101
    v_cvt_pk_bf16_f32 v111, v102, v103
    ds_write_b128 v22, v[108:111] offset:2560
    v_mfma_f32_32x32x16_bf16 a[240:255], a[44:47], a[56:59], a[240:255]
    v_accvgpr_read_b32 v160, a224
    v_accvgpr_read_b32 v161, a225
    v_accvgpr_read_b32 v162, a226
    v_accvgpr_read_b32 v163, a227
    v_accvgpr_read_b32 v164, a228
    v_accvgpr_read_b32 v165, a229
    v_accvgpr_read_b32 v166, a230
    v_accvgpr_read_b32 v167, a231
    v_accvgpr_read_b32 v168, a232
    v_accvgpr_read_b32 v169, a233
    v_accvgpr_read_b32 v170, a234
    v_mfma_f32_32x32x16_bf16 a[192:207], a[60:63], a[76:79], a[192:207]
    buffer_load_dwordx4 v15, s[36:39], s61 offen offset:3072  lds
    v_accvgpr_read_b32 v171, a235
    v_accvgpr_read_b32 v172, a236
    v_accvgpr_read_b32 v173, a237
    v_accvgpr_read_b32 v174, a238
    v_accvgpr_read_b32 v175, a239
    v_mul_f32 v160, v160, v41
    v_mul_f32 v161, v161, v41
    v_mul_f32 v162, v162, v41
    v_mul_f32 v163, v163, v41
    v_mul_f32 v164, v164, v41
    v_mul_f32 v165, v165, v41
    v_mfma_f32_32x32x16_bf16 a[240:255], a[64:67], a[76:79], a[240:255]
    v_mul_f32 v166, v166, v41
    v_mul_f32 v167, v167, v41
    v_mul_f32 v168, v168, v41
    v_mul_f32 v169, v169, v41
    v_mul_f32 v170, v170, v41
    v_mul_f32 v171, v171, v41
    v_mul_f32 v172, v172, v41
    v_mul_f32 v173, v173, v41
    v_mul_f32 v174, v174, v41
    v_mul_f32 v175, v175, v41
    v_cvt_pk_bf16_f32 v176, v160, v161
    v_lshrrev_b32 v56, 5, v1
    v_bfe_u32 v57, v1, 4, 1
    v_bfe_u32 v58, v1, 2, 2
    v_and_b32 v59, 3, v1
    v_lshlrev_b32 v60, 4, v56
    v_lshl_add_u32 v60, v57, 2, v60
    v_add_u32 v60, v60, v58
    v_lshrrev_b32 v61, 1, v58
    v_lshl_add_u32 v61, v57, 1, v61
    v_and_b32 v61, 3, v61
    v_lshlrev_b32 v61, 1, v61
    v_lshrrev_b32 v62, 1, v59
    s_lshl_b32 s56, s48, 1
    v_add_u32 v62, s56, v62
    v_xor_b32 v62, v62, v61
    v_lshlrev_b32 v60, 7, v60
    v_lshl_add_u32 v60, v62, 4, v60
    v_and_b32 v59, 1, v59
    v_lshl_add_u32 v60, v59, 3, v60
    v_add_u32 v18, 0, v60
    v_add_u32 v19, 98304, v60
    s_lshl_b32 s56, s49, 4
    s_add_u32 s56, s56, s50
    s_mul_i32 s70, s56, 86016
    s_mul_i32 s56, s48, 3072
    s_add_u32 s70, s70, s56
    v_cvt_pk_bf16_f32 v177, v162, v163
    v_cvt_pk_bf16_f32 v178, v164, v165
    v_cvt_pk_bf16_f32 v179, v166, v167
    ds_write_b128 v22, v[176:179] offset:8192
    v_cvt_pk_bf16_f32 v180, v168, v169
    v_cvt_pk_bf16_f32 v181, v170, v171
    v_cvt_pk_bf16_f32 v182, v172, v173
    v_cvt_pk_bf16_f32 v183, v174, v175
    ds_write_b128 v22, v[180:183] offset:8704
    v_accvgpr_read_b32 v112, a192
    v_accvgpr_read_b32 v113, a193
    v_accvgpr_read_b32 v114, a194
    v_accvgpr_read_b32 v115, a195
    v_accvgpr_read_b32 v116, a196
    v_accvgpr_read_b32 v117, a197
    v_accvgpr_read_b32 v118, a198
    v_accvgpr_read_b32 v119, a199
    v_accvgpr_read_b32 v120, a200
    v_accvgpr_read_b32 v121, a201
    v_accvgpr_read_b32 v122, a202
    v_accvgpr_read_b32 v123, a203
    v_accvgpr_read_b32 v124, a204
    v_accvgpr_read_b32 v125, a205
    v_accvgpr_read_b32 v126, a206
    v_accvgpr_read_b32 v127, a207
    v_mul_f32 v112, v112, v42
    v_mul_f32 v113, v113, v42
    v_mul_f32 v114, v114, v42
    v_mul_f32 v115, v115, v42
    v_mul_f32 v116, v116, v42
    v_mul_f32 v117, v117, v42
    v_mul_f32 v118, v118, v42
    v_mul_f32 v119, v119, v42
    v_mul_f32 v120, v120, v42
    v_mul_f32 v121, v121, v42
    v_mul_f32 v122, v122, v42
    v_mul_f32 v123, v123, v42
    v_mul_f32 v124, v124, v42
    v_mul_f32 v125, v125, v42
    v_mul_f32 v126, v126, v42
    v_mul_f32 v127, v127, v42
    v_cvt_pk_bf16_f32 v128, v112, v113
    v_cvt_pk_bf16_f32 v129, v114, v115
    v_cvt_pk_bf16_f32 v130, v116, v117
    v_cvt_pk_bf16_f32 v131, v118, v119
    ds_write_b128 v22, v[128:131] offset:4096
    v_cvt_pk_bf16_f32 v132, v120, v121
    v_cvt_pk_bf16_f32 v133, v122, v123
    v_cvt_pk_bf16_f32 v134, v124, v125
    v_cvt_pk_bf16_f32 v135, v126, v127
    ds_write_b128 v22, v[132:135] offset:4608
    v_accvgpr_read_b32 v184, a240
    v_accvgpr_read_b32 v185, a241
    v_accvgpr_read_b32 v186, a242
    v_accvgpr_read_b32 v187, a243
    v_accvgpr_read_b32 v188, a244
    v_accvgpr_read_b32 v189, a245
    v_accvgpr_read_b32 v190, a246
    v_accvgpr_read_b32 v191, a247
    v_accvgpr_read_b32 v192, a248
    v_accvgpr_read_b32 v193, a249
    v_accvgpr_read_b32 v194, a250
    v_accvgpr_read_b32 v195, a251
    v_accvgpr_read_b32 v196, a252
    v_accvgpr_read_b32 v197, a253
    v_accvgpr_read_b32 v198, a254
    v_accvgpr_read_b32 v199, a255
    v_mul_f32 v184, v184, v42
    v_mul_f32 v185, v185, v42
    v_mul_f32 v186, v186, v42
    v_mul_f32 v187, v187, v42
    v_mul_f32 v188, v188, v42
    v_mul_f32 v189, v189, v42
    v_mul_f32 v190, v190, v42
    v_mul_f32 v191, v191, v42
    v_mul_f32 v192, v192, v42
    v_mul_f32 v193, v193, v42
    v_mul_f32 v194, v194, v42
    v_mul_f32 v195, v195, v42
    v_mul_f32 v196, v196, v42
    v_mul_f32 v197, v197, v42
    v_mul_f32 v198, v198, v42
    v_mul_f32 v199, v199, v42
    v_cvt_pk_bf16_f32 v200, v184, v185
    v_cvt_pk_bf16_f32 v201, v186, v187
    v_cvt_pk_bf16_f32 v202, v188, v189
    v_cvt_pk_bf16_f32 v203, v190, v191
    ds_write_b128 v22, v[200:203] offset:10240
    v_cvt_pk_bf16_f32 v204, v192, v193
    v_cvt_pk_bf16_f32 v205, v194, v195
    v_cvt_pk_bf16_f32 v206, v196, v197
    v_cvt_pk_bf16_f32 v207, v198, v199
    ds_write_b128 v22, v[204:207] offset:10752
    s_waitcnt vmcnt(16)
    s_waitcnt lgkmcnt(0)
    s_barrier
    ds_read_b128 a[64:67], v3 offset:0
    ds_read_b128 a[68:71], v3 offset:1024
    ds_read_b128 a[72:75], v3 offset:2048
    ds_read_b128 a[76:79], v3 offset:3072
    ds_read_b128 a[80:83], v3 offset:4096
    ds_read_b128 a[84:87], v3 offset:5120
    ds_read_b64_tr_b16 a[0:1], v19 offset:8192
    ds_read_b64_tr_b16 a[2:3], v19 offset:9216
    ds_read_b64_tr_b16 a[4:5], v19 offset:12288
    ds_read_b64_tr_b16 a[6:7], v19 offset:13312
    ds_read_b128 a[88:91], v3 offset:6144
    ds_read_b128 a[92:95], v3 offset:7168
    ds_read_b128 a[96:99], v3 offset:8192
    ds_read_b128 a[100:103], v3 offset:9216
    ds_read_b128 a[104:107], v3 offset:10240
    ds_read_b128 a[108:111], v3 offset:11264
    s_waitcnt lgkmcnt(10)
    s_waitcnt lgkmcnt(8)
    v_mfma_f32_16x16x32_bf16 v[88:91], a[0:3], a[64:67], 0
    ds_read_b128 a[112:115], v3 offset:12288
    ds_read_b128 a[116:119], v3 offset:13312
    v_mfma_f32_16x16x32_bf16 v[92:95], a[0:3], a[68:71], 0
    ds_read_b64_tr_b16 a[8:9], v19 offset:24576
    ds_read_b128 a[120:123], v3 offset:14336
    v_mfma_f32_16x16x32_bf16 v[96:99], a[0:3], a[72:75], 0
    ds_read_b64_tr_b16 a[10:11], v19 offset:25600
    ds_read_b128 a[124:127], v3 offset:15360
    v_mfma_f32_16x16x32_bf16 v[100:103], a[0:3], a[76:79], 0
    ds_read_b128 a[128:131], v3 offset:16384
    ds_read_b128 a[132:135], v3 offset:17408
    v_mfma_f32_16x16x32_bf16 v[104:107], a[0:3], a[80:83], 0
    v_mfma_f32_16x16x32_bf16 v[108:111], a[0:3], a[84:87], 0
    s_waitcnt lgkmcnt(8)
    v_mfma_f32_16x16x32_bf16 v[88:91], a[4:7], a[88:91], v[88:91]
    ds_read_b128 a[136:139], v3 offset:18432
    ds_read_b128 a[140:143], v3 offset:19456
    v_mfma_f32_16x16x32_bf16 v[92:95], a[4:7], a[92:95], v[92:95]
    ds_read_b64_tr_b16 a[12:13], v19 offset:28672
    ds_read_b128 a[144:147], v3 offset:20480
    v_mfma_f32_16x16x32_bf16 v[96:99], a[4:7], a[96:99], v[96:99]
    ds_read_b64_tr_b16 a[14:15], v19 offset:29696
    ds_read_b128 a[148:151], v3 offset:21504
    v_mfma_f32_16x16x32_bf16 v[100:103], a[4:7], a[100:103], v[100:103]
    ds_read_b128 a[152:155], v3 offset:22528
    ds_read_b128 a[156:159], v3 offset:23552
    v_mfma_f32_16x16x32_bf16 v[104:107], a[4:7], a[104:107], v[104:107]
    v_mfma_f32_16x16x32_bf16 v[108:111], a[4:7], a[108:111], v[108:111]
    s_waitcnt lgkmcnt(8)
    v_mfma_f32_16x16x32_bf16 v[88:91], a[8:11], a[112:115], v[88:91]
    ds_read_b128 a[160:163], v3 offset:24576
    ds_read_b128 a[164:167], v3 offset:25600
    v_mfma_f32_16x16x32_bf16 v[92:95], a[8:11], a[116:119], v[92:95]
    ds_read_b64_tr_b16 a[0:1], v19 offset:40960
    ds_read_b128 a[168:171], v3 offset:26624
    v_mfma_f32_16x16x32_bf16 v[96:99], a[8:11], a[120:123], v[96:99]
    ds_read_b64_tr_b16 a[2:3], v19 offset:41984
    ds_read_b128 a[172:175], v3 offset:27648
    v_mfma_f32_16x16x32_bf16 v[100:103], a[8:11], a[124:127], v[100:103]
    ds_read_b128 a[176:179], v3 offset:28672
    ds_read_b128 a[180:183], v3 offset:29696
    v_mfma_f32_16x16x32_bf16 v[104:107], a[8:11], a[128:131], v[104:107]
    v_mfma_f32_16x16x32_bf16 v[108:111], a[8:11], a[132:135], v[108:111]
    s_waitcnt lgkmcnt(8)
    v_mfma_f32_16x16x32_bf16 v[88:91], a[12:15], a[136:139], v[88:91]
    ds_read_b128 a[184:187], v3 offset:30720
    ds_read_b128 a[188:191], v3 offset:31744
    v_mfma_f32_16x16x32_bf16 v[92:95], a[12:15], a[140:143], v[92:95]
    ds_read_b64_tr_b16 a[4:5], v19 offset:45056
    ds_read_b128 a[192:195], v3 offset:32768
    v_mfma_f32_16x16x32_bf16 v[96:99], a[12:15], a[144:147], v[96:99]
    ds_read_b64_tr_b16 a[6:7], v19 offset:46080
    ds_read_b128 a[196:199], v3 offset:33792
    v_mfma_f32_16x16x32_bf16 v[100:103], a[12:15], a[148:151], v[100:103]
    ds_read_b128 a[200:203], v3 offset:34816
    ds_read_b128 a[204:207], v3 offset:35840
    v_mfma_f32_16x16x32_bf16 v[104:107], a[12:15], a[152:155], v[104:107]
    v_mfma_f32_16x16x32_bf16 v[108:111], a[12:15], a[156:159], v[108:111]
    s_waitcnt lgkmcnt(8)
    v_mfma_f32_16x16x32_bf16 v[88:91], a[0:3], a[160:163], v[88:91]
    ds_read_b128 a[208:211], v3 offset:36864
    ds_read_b128 a[212:215], v3 offset:37888
    v_mfma_f32_16x16x32_bf16 v[92:95], a[0:3], a[164:167], v[92:95]
    ds_read_b64_tr_b16 a[8:9], v19 offset:57344
    ds_read_b128 a[216:219], v3 offset:38912
    v_mfma_f32_16x16x32_bf16 v[96:99], a[0:3], a[168:171], v[96:99]
    ds_read_b64_tr_b16 a[10:11], v19 offset:58368
    ds_read_b128 a[220:223], v3 offset:39936
    v_mfma_f32_16x16x32_bf16 v[100:103], a[0:3], a[172:175], v[100:103]
    ds_read_b128 a[224:227], v3 offset:40960
    ds_read_b128 a[228:231], v3 offset:41984
    v_mfma_f32_16x16x32_bf16 v[104:107], a[0:3], a[176:179], v[104:107]
    v_mfma_f32_16x16x32_bf16 v[108:111], a[0:3], a[180:183], v[108:111]
    s_waitcnt lgkmcnt(8)
    v_mfma_f32_16x16x32_bf16 v[88:91], a[4:7], a[184:187], v[88:91]
    ds_read_b128 a[232:235], v3 offset:43008
    ds_read_b128 a[236:239], v3 offset:44032
    v_mfma_f32_16x16x32_bf16 v[92:95], a[4:7], a[188:191], v[92:95]
    ds_read_b64_tr_b16 a[12:13], v19 offset:61440
    ds_read_b128 a[240:243], v3 offset:45056
    v_mfma_f32_16x16x32_bf16 v[96:99], a[4:7], a[192:195], v[96:99]
    ds_read_b64_tr_b16 a[14:15], v19 offset:62464
    ds_read_b128 a[244:247], v3 offset:46080
    v_mfma_f32_16x16x32_bf16 v[100:103], a[4:7], a[196:199], v[100:103]
    ds_read_b128 a[248:251], v3 offset:47104
    ds_read_b128 a[252:255], v3 offset:48128
    v_mfma_f32_16x16x32_bf16 v[104:107], a[4:7], a[200:203], v[104:107]
    v_mfma_f32_16x16x32_bf16 v[108:111], a[4:7], a[204:207], v[108:111]
    s_waitcnt lgkmcnt(8)
    v_mfma_f32_16x16x32_bf16 v[88:91], a[8:11], a[208:211], v[88:91]
    v_mfma_f32_16x16x32_bf16 v[92:95], a[8:11], a[212:215], v[92:95]
    v_mfma_f32_16x16x32_bf16 v[96:99], a[8:11], a[216:219], v[96:99]
    v_mfma_f32_16x16x32_bf16 v[100:103], a[8:11], a[220:223], v[100:103]
    v_mfma_f32_16x16x32_bf16 v[104:107], a[8:11], a[224:227], v[104:107]
    v_mfma_f32_16x16x32_bf16 v[108:111], a[8:11], a[228:231], v[108:111]
    s_waitcnt lgkmcnt(0)
    s_waitcnt vmcnt(8)
    s_barrier
    v_mfma_f32_16x16x32_bf16 v[88:91], a[12:15], a[232:235], v[88:91]
    ds_read_b64_tr_b16 a[0:1], v19 offset:0
    ds_read_b64_tr_b16 a[2:3], v19 offset:1024
    v_mfma_f32_16x16x32_bf16 v[92:95], a[12:15], a[236:239], v[92:95]
    s_add_u32 m0, s52, 8192
    s_add_u32 s61, s55, s65
    buffer_load_dwordx4 v12, s[36:39], s61 offen offset:0  lds
    v_mfma_f32_16x16x32_bf16 v[96:99], a[12:15], a[240:243], v[96:99]
    ds_read_b64_tr_b16 a[4:5], v19 offset:4096
    ds_read_b64_tr_b16 a[6:7], v19 offset:5120
    v_mfma_f32_16x16x32_bf16 v[100:103], a[12:15], a[244:247], v[100:103]
    v_mfma_f32_16x16x32_bf16 v[104:107], a[12:15], a[248:251], v[104:107]
    v_mfma_f32_16x16x32_bf16 v[108:111], a[12:15], a[252:255], v[108:111]
    buffer_load_dwordx4 v13, s[36:39], s61 offen offset:1024  lds
    s_waitcnt lgkmcnt(2)
    v_mfma_f32_16x16x32_bf16 v[64:67], a[0:3], a[64:67], 0
    ds_read_b64_tr_b16 a[8:9], v19 offset:16384
    ds_read_b64_tr_b16 a[10:11], v19 offset:17408
    v_mfma_f32_16x16x32_bf16 v[68:71], a[0:3], a[68:71], 0
    v_mfma_f32_16x16x32_bf16 v[72:75], a[0:3], a[72:75], 0
    v_mfma_f32_16x16x32_bf16 v[76:79], a[0:3], a[76:79], 0
    buffer_load_dwordx4 v14, s[36:39], s61 offen offset:2048  lds
    v_cvt_pk_bf16_f32 v128, v88, v89
    v_mfma_f32_16x16x32_bf16 v[80:83], a[0:3], a[80:83], 0
    v_cvt_pk_bf16_f32 v129, v90, v91
    v_cvt_pk_bf16_f32 v130, v92, v93
    v_mfma_f32_16x16x32_bf16 v[84:87], a[0:3], a[84:87], 0
    v_cvt_pk_bf16_f32 v131, v94, v95
    s_add_u32 s71, s70, 0
    s_waitcnt lgkmcnt(2)
    v_mfma_f32_16x16x32_bf16 v[64:67], a[4:7], a[88:91], v[64:67]
    ds_read_b64_tr_b16 a[12:13], v19 offset:20480
    ds_read_b64_tr_b16 a[14:15], v19 offset:21504
    v_mfma_f32_16x16x32_bf16 v[68:71], a[4:7], a[92:95], v[68:71]
    buffer_store_dwordx4 v[128:131], v2, s[40:43], s71 offen offset:0 sc1
    v_cvt_pk_bf16_f32 v132, v96, v97
    v_mfma_f32_16x16x32_bf16 v[72:75], a[4:7], a[96:99], v[72:75]
    v_cvt_pk_bf16_f32 v133, v98, v99
    v_cvt_pk_bf16_f32 v134, v100, v101
    v_mfma_f32_16x16x32_bf16 v[76:79], a[4:7], a[100:103], v[76:79]
    v_cvt_pk_bf16_f32 v135, v102, v103
    v_mfma_f32_16x16x32_bf16 v[80:83], a[4:7], a[104:107], v[80:83]
    v_mfma_f32_16x16x32_bf16 v[84:87], a[4:7], a[108:111], v[84:87]
    buffer_load_dwordx4 v15, s[36:39], s61 offen offset:3072  lds
    s_waitcnt lgkmcnt(2)
    v_mfma_f32_16x16x32_bf16 v[64:67], a[8:11], a[112:115], v[64:67]
    ds_read_b64_tr_b16 a[0:1], v19 offset:32768
    ds_read_b64_tr_b16 a[2:3], v19 offset:33792
    v_mfma_f32_16x16x32_bf16 v[68:71], a[8:11], a[116:119], v[68:71]
    v_mfma_f32_16x16x32_bf16 v[72:75], a[8:11], a[120:123], v[72:75]
    v_mfma_f32_16x16x32_bf16 v[76:79], a[8:11], a[124:127], v[76:79]
    s_add_u32 m0, s52, 12288
    s_add_u32 s61, s55, s65
    s_add_u32 s61, s61, 28672
    buffer_load_dwordx4 v12, s[36:39], s61 offen offset:0  lds
    v_mfma_f32_16x16x32_bf16 v[80:83], a[8:11], a[128:131], v[80:83]
    v_mfma_f32_16x16x32_bf16 v[84:87], a[8:11], a[132:135], v[84:87]
    s_waitcnt lgkmcnt(2)
    v_mfma_f32_16x16x32_bf16 v[64:67], a[12:15], a[136:139], v[64:67]
    ds_read_b64_tr_b16 a[4:5], v19 offset:36864
    ds_read_b64_tr_b16 a[6:7], v19 offset:37888
    v_mfma_f32_16x16x32_bf16 v[68:71], a[12:15], a[140:143], v[68:71]
    buffer_load_dwordx4 v13, s[36:39], s61 offen offset:1024  lds
    v_mfma_f32_16x16x32_bf16 v[72:75], a[12:15], a[144:147], v[72:75]
    v_mfma_f32_16x16x32_bf16 v[76:79], a[12:15], a[148:151], v[76:79]
    v_mfma_f32_16x16x32_bf16 v[80:83], a[12:15], a[152:155], v[80:83]
    v_mfma_f32_16x16x32_bf16 v[84:87], a[12:15], a[156:159], v[84:87]
    buffer_store_dwordx4 v[132:135], v2, s[40:43], s71 offen offset:1024 sc1
    v_cvt_pk_bf16_f32 v136, v104, v105
    s_waitcnt lgkmcnt(2)
    v_mfma_f32_16x16x32_bf16 v[64:67], a[0:3], a[160:163], v[64:67]
    ds_read_b64_tr_b16 a[8:9], v19 offset:49152
    ds_read_b64_tr_b16 a[10:11], v19 offset:50176
    v_mfma_f32_16x16x32_bf16 v[68:71], a[0:3], a[164:167], v[68:71]
    v_cvt_pk_bf16_f32 v137, v106, v107
    v_cvt_pk_bf16_f32 v138, v108, v109
    v_mfma_f32_16x16x32_bf16 v[72:75], a[0:3], a[168:171], v[72:75]
    v_cvt_pk_bf16_f32 v139, v110, v111
    v_mfma_f32_16x16x32_bf16 v[76:79], a[0:3], a[172:175], v[76:79]
    buffer_load_dwordx4 v14, s[36:39], s61 offen offset:2048  lds
    v_mfma_f32_16x16x32_bf16 v[80:83], a[0:3], a[176:179], v[80:83]
    v_mfma_f32_16x16x32_bf16 v[84:87], a[0:3], a[180:183], v[84:87]
    s_waitcnt lgkmcnt(2)
    v_mfma_f32_16x16x32_bf16 v[64:67], a[4:7], a[184:187], v[64:67]
    ds_read_b64_tr_b16 a[12:13], v19 offset:53248
    ds_read_b64_tr_b16 a[14:15], v19 offset:54272
    v_mfma_f32_16x16x32_bf16 v[68:71], a[4:7], a[188:191], v[68:71]
    buffer_load_dwordx4 v15, s[36:39], s61 offen offset:3072  lds
    v_mfma_f32_16x16x32_bf16 v[72:75], a[4:7], a[192:195], v[72:75]
    v_mfma_f32_16x16x32_bf16 v[76:79], a[4:7], a[196:199], v[76:79]
    v_mfma_f32_16x16x32_bf16 v[80:83], a[4:7], a[200:203], v[80:83]
    v_mfma_f32_16x16x32_bf16 v[84:87], a[4:7], a[204:207], v[84:87]
    buffer_store_dwordx4 v[136:139], v2, s[40:43], s71 offen offset:2048 sc1
    s_waitcnt lgkmcnt(2)
    v_mfma_f32_16x16x32_bf16 v[64:67], a[8:11], a[208:211], v[64:67]
    v_mfma_f32_16x16x32_bf16 v[68:71], a[8:11], a[212:215], v[68:71]
    v_mfma_f32_16x16x32_bf16 v[72:75], a[8:11], a[216:219], v[72:75]
    v_mfma_f32_16x16x32_bf16 v[76:79], a[8:11], a[220:223], v[76:79]
    v_mfma_f32_16x16x32_bf16 v[80:83], a[8:11], a[224:227], v[80:83]
    v_mfma_f32_16x16x32_bf16 v[84:87], a[8:11], a[228:231], v[84:87]
    s_waitcnt lgkmcnt(0)
    s_waitcnt vmcnt(11)
    s_barrier
    v_mfma_f32_16x16x32_bf16 v[64:67], a[12:15], a[232:235], v[64:67]
    ds_read_b64_tr_b16 a[0:1], v18 offset:0
    ds_read_b64_tr_b16 a[2:3], v18 offset:1024
    v_mfma_f32_16x16x32_bf16 v[68:71], a[12:15], a[236:239], v[68:71]
    s_add_u32 m0, s52, 0
    s_add_u32 s61, s55, s66
    buffer_load_dwordx4 v12, s[36:39], s61 offen offset:0  lds
    v_mfma_f32_16x16x32_bf16 v[72:75], a[12:15], a[240:243], v[72:75]
    ds_read_b64_tr_b16 a[4:5], v18 offset:4096
    ds_read_b64_tr_b16 a[6:7], v18 offset:5120
    v_mfma_f32_16x16x32_bf16 v[76:79], a[12:15], a[244:247], v[76:79]
    v_mfma_f32_16x16x32_bf16 v[80:83], a[12:15], a[248:251], v[80:83]
    v_mfma_f32_16x16x32_bf16 v[84:87], a[12:15], a[252:255], v[84:87]
    buffer_load_dwordx4 v13, s[36:39], s61 offen offset:1024  lds
    s_waitcnt lgkmcnt(2)
    v_mfma_f32_16x16x32_bf16 v[88:91], a[0:3], a[64:67], 0
    ds_read_b64_tr_b16 a[8:9], v18 offset:8192
    ds_read_b64_tr_b16 a[10:11], v18 offset:9216
    v_mfma_f32_16x16x32_bf16 v[92:95], a[0:3], a[68:71], 0
    v_mfma_f32_16x16x32_bf16 v[96:99], a[0:3], a[72:75], 0
    v_mfma_f32_16x16x32_bf16 v[100:103], a[0:3], a[76:79], 0
    buffer_load_dwordx4 v14, s[36:39], s61 offen offset:2048  lds
    v_cvt_pk_bf16_f32 v128, v64, v65
    v_mfma_f32_16x16x32_bf16 v[104:107], a[0:3], a[80:83], 0
    v_cvt_pk_bf16_f32 v129, v66, v67
    v_cvt_pk_bf16_f32 v130, v68, v69
    v_mfma_f32_16x16x32_bf16 v[108:111], a[0:3], a[84:87], 0
    v_cvt_pk_bf16_f32 v131, v70, v71
    s_add_u32 s71, s70, 12288
    s_waitcnt lgkmcnt(2)
    v_mfma_f32_16x16x32_bf16 v[88:91], a[4:7], a[88:91], v[88:91]
    ds_read_b64_tr_b16 a[12:13], v18 offset:12288
    ds_read_b64_tr_b16 a[14:15], v18 offset:13312
    v_mfma_f32_16x16x32_bf16 v[92:95], a[4:7], a[92:95], v[92:95]
    buffer_store_dwordx4 v[128:131], v2, s[40:43], s71 offen offset:0 sc1
    v_cvt_pk_bf16_f32 v132, v72, v73
    v_mfma_f32_16x16x32_bf16 v[96:99], a[4:7], a[96:99], v[96:99]
    v_cvt_pk_bf16_f32 v133, v74, v75
    v_cvt_pk_bf16_f32 v134, v76, v77
    v_mfma_f32_16x16x32_bf16 v[100:103], a[4:7], a[100:103], v[100:103]
    v_cvt_pk_bf16_f32 v135, v78, v79
    v_mfma_f32_16x16x32_bf16 v[104:107], a[4:7], a[104:107], v[104:107]
    v_mfma_f32_16x16x32_bf16 v[108:111], a[4:7], a[108:111], v[108:111]
    buffer_load_dwordx4 v15, s[36:39], s61 offen offset:3072  lds
    s_waitcnt lgkmcnt(2)
    v_mfma_f32_16x16x32_bf16 v[88:91], a[8:11], a[112:115], v[88:91]
    ds_read_b64_tr_b16 a[0:1], v18 offset:16384
    ds_read_b64_tr_b16 a[2:3], v18 offset:17408
    v_mfma_f32_16x16x32_bf16 v[92:95], a[8:11], a[116:119], v[92:95]
    v_mfma_f32_16x16x32_bf16 v[96:99], a[8:11], a[120:123], v[96:99]
    v_mfma_f32_16x16x32_bf16 v[100:103], a[8:11], a[124:127], v[100:103]
    s_add_u32 m0, s52, 4096
    s_add_u32 s61, s55, s66
    s_add_u32 s61, s61, 28672
    buffer_load_dwordx4 v12, s[36:39], s61 offen offset:0  lds
    v_mfma_f32_16x16x32_bf16 v[104:107], a[8:11], a[128:131], v[104:107]
    v_mfma_f32_16x16x32_bf16 v[108:111], a[8:11], a[132:135], v[108:111]
    s_waitcnt lgkmcnt(2)
    v_mfma_f32_16x16x32_bf16 v[88:91], a[12:15], a[136:139], v[88:91]
    ds_read_b64_tr_b16 a[4:5], v18 offset:20480
    ds_read_b64_tr_b16 a[6:7], v18 offset:21504
    v_mfma_f32_16x16x32_bf16 v[92:95], a[12:15], a[140:143], v[92:95]
    buffer_load_dwordx4 v13, s[36:39], s61 offen offset:1024  lds
    v_mfma_f32_16x16x32_bf16 v[96:99], a[12:15], a[144:147], v[96:99]
    v_mfma_f32_16x16x32_bf16 v[100:103], a[12:15], a[148:151], v[100:103]
    v_mfma_f32_16x16x32_bf16 v[104:107], a[12:15], a[152:155], v[104:107]
    v_mfma_f32_16x16x32_bf16 v[108:111], a[12:15], a[156:159], v[108:111]
    buffer_store_dwordx4 v[132:135], v2, s[40:43], s71 offen offset:1024 sc1
    v_cvt_pk_bf16_f32 v136, v80, v81
    s_waitcnt lgkmcnt(2)
    v_mfma_f32_16x16x32_bf16 v[88:91], a[0:3], a[160:163], v[88:91]
    ds_read_b64_tr_b16 a[8:9], v18 offset:24576
    ds_read_b64_tr_b16 a[10:11], v18 offset:25600
    v_mfma_f32_16x16x32_bf16 v[92:95], a[0:3], a[164:167], v[92:95]
    v_cvt_pk_bf16_f32 v137, v82, v83
    v_cvt_pk_bf16_f32 v138, v84, v85
    v_mfma_f32_16x16x32_bf16 v[96:99], a[0:3], a[168:171], v[96:99]
    v_cvt_pk_bf16_f32 v139, v86, v87
    v_mfma_f32_16x16x32_bf16 v[100:103], a[0:3], a[172:175], v[100:103]
    buffer_load_dwordx4 v14, s[36:39], s61 offen offset:2048  lds
    v_mfma_f32_16x16x32_bf16 v[104:107], a[0:3], a[176:179], v[104:107]
    v_mfma_f32_16x16x32_bf16 v[108:111], a[0:3], a[180:183], v[108:111]
    s_waitcnt lgkmcnt(2)
    v_mfma_f32_16x16x32_bf16 v[88:91], a[4:7], a[184:187], v[88:91]
    ds_read_b64_tr_b16 a[12:13], v18 offset:28672
    ds_read_b64_tr_b16 a[14:15], v18 offset:29696
    v_mfma_f32_16x16x32_bf16 v[92:95], a[4:7], a[188:191], v[92:95]
    buffer_load_dwordx4 v15, s[36:39], s61 offen offset:3072  lds
    v_mfma_f32_16x16x32_bf16 v[96:99], a[4:7], a[192:195], v[96:99]
    v_mfma_f32_16x16x32_bf16 v[100:103], a[4:7], a[196:199], v[100:103]
    v_mfma_f32_16x16x32_bf16 v[104:107], a[4:7], a[200:203], v[104:107]
    v_mfma_f32_16x16x32_bf16 v[108:111], a[4:7], a[204:207], v[108:111]
    buffer_store_dwordx4 v[136:139], v2, s[40:43], s71 offen offset:2048 sc1
    s_waitcnt lgkmcnt(2)
    v_mfma_f32_16x16x32_bf16 v[88:91], a[8:11], a[208:211], v[88:91]
    v_mfma_f32_16x16x32_bf16 v[92:95], a[8:11], a[212:215], v[92:95]
    v_mfma_f32_16x16x32_bf16 v[96:99], a[8:11], a[216:219], v[96:99]
    v_mfma_f32_16x16x32_bf16 v[100:103], a[8:11], a[220:223], v[100:103]
    v_mfma_f32_16x16x32_bf16 v[104:107], a[8:11], a[224:227], v[104:107]
    v_mfma_f32_16x16x32_bf16 v[108:111], a[8:11], a[228:231], v[108:111]
    s_waitcnt lgkmcnt(0)
    s_waitcnt vmcnt(12)
    s_barrier
    v_mfma_f32_16x16x32_bf16 v[88:91], a[12:15], a[232:235], v[88:91]
    ds_read_b64_tr_b16 a[0:1], v19 offset:8192
    ds_read_b64_tr_b16 a[2:3], v19 offset:9216
    v_mfma_f32_16x16x32_bf16 v[92:95], a[12:15], a[236:239], v[92:95]
    s_add_u32 m0, s53, 0
    s_add_u32 s61, s55, s67
    buffer_load_dwordx4 v12, s[36:39], s61 offen offset:0  lds
    v_mfma_f32_16x16x32_bf16 v[96:99], a[12:15], a[240:243], v[96:99]
    ds_read_b64_tr_b16 a[4:5], v19 offset:12288
    ds_read_b64_tr_b16 a[6:7], v19 offset:13312
    v_mfma_f32_16x16x32_bf16 v[100:103], a[12:15], a[244:247], v[100:103]
    v_mfma_f32_16x16x32_bf16 v[104:107], a[12:15], a[248:251], v[104:107]
    v_mfma_f32_16x16x32_bf16 v[108:111], a[12:15], a[252:255], v[108:111]
    buffer_load_dwordx4 v13, s[36:39], s61 offen offset:1024  lds
    s_waitcnt lgkmcnt(2)
    v_mfma_f32_16x16x32_bf16 v[64:67], a[0:3], a[64:67], 0
    ds_read_b64_tr_b16 a[8:9], v19 offset:24576
    ds_read_b64_tr_b16 a[10:11], v19 offset:25600
    v_mfma_f32_16x16x32_bf16 v[68:71], a[0:3], a[68:71], 0
    v_mfma_f32_16x16x32_bf16 v[72:75], a[0:3], a[72:75], 0
    v_mfma_f32_16x16x32_bf16 v[76:79], a[0:3], a[76:79], 0
    buffer_load_dwordx4 v14, s[36:39], s61 offen offset:2048  lds
    v_cvt_pk_bf16_f32 v128, v88, v89
    v_mfma_f32_16x16x32_bf16 v[80:83], a[0:3], a[80:83], 0
    v_cvt_pk_bf16_f32 v129, v90, v91
    v_cvt_pk_bf16_f32 v130, v92, v93
    v_mfma_f32_16x16x32_bf16 v[84:87], a[0:3], a[84:87], 0
    v_cvt_pk_bf16_f32 v131, v94, v95
    s_add_u32 s71, s70, 24576
    s_waitcnt lgkmcnt(2)
    v_mfma_f32_16x16x32_bf16 v[64:67], a[4:7], a[88:91], v[64:67]
    ds_read_b64_tr_b16 a[12:13], v19 offset:28672
    ds_read_b64_tr_b16 a[14:15], v19 offset:29696
    v_mfma_f32_16x16x32_bf16 v[68:71], a[4:7], a[92:95], v[68:71]
    buffer_store_dwordx4 v[128:131], v2, s[40:43], s71 offen offset:0 sc1
    v_cvt_pk_bf16_f32 v132, v96, v97
    v_mfma_f32_16x16x32_bf16 v[72:75], a[4:7], a[96:99], v[72:75]
    v_cvt_pk_bf16_f32 v133, v98, v99
    v_cvt_pk_bf16_f32 v134, v100, v101
    v_mfma_f32_16x16x32_bf16 v[76:79], a[4:7], a[100:103], v[76:79]
    v_cvt_pk_bf16_f32 v135, v102, v103
    v_mfma_f32_16x16x32_bf16 v[80:83], a[4:7], a[104:107], v[80:83]
    v_mfma_f32_16x16x32_bf16 v[84:87], a[4:7], a[108:111], v[84:87]
    buffer_load_dwordx4 v15, s[36:39], s61 offen offset:3072  lds
    s_waitcnt lgkmcnt(2)
    v_mfma_f32_16x16x32_bf16 v[64:67], a[8:11], a[112:115], v[64:67]
    ds_read_b64_tr_b16 a[0:1], v19 offset:40960
    ds_read_b64_tr_b16 a[2:3], v19 offset:41984
    v_mfma_f32_16x16x32_bf16 v[68:71], a[8:11], a[116:119], v[68:71]
    v_mfma_f32_16x16x32_bf16 v[72:75], a[8:11], a[120:123], v[72:75]
    v_mfma_f32_16x16x32_bf16 v[76:79], a[8:11], a[124:127], v[76:79]
    s_add_u32 m0, s53, 4096
    s_add_u32 s61, s55, s67
    s_add_u32 s61, s61, 28672
    buffer_load_dwordx4 v12, s[36:39], s61 offen offset:0  lds
    v_mfma_f32_16x16x32_bf16 v[80:83], a[8:11], a[128:131], v[80:83]
    v_mfma_f32_16x16x32_bf16 v[84:87], a[8:11], a[132:135], v[84:87]
    s_waitcnt lgkmcnt(2)
    v_mfma_f32_16x16x32_bf16 v[64:67], a[12:15], a[136:139], v[64:67]
    ds_read_b64_tr_b16 a[4:5], v19 offset:45056
    ds_read_b64_tr_b16 a[6:7], v19 offset:46080
    v_mfma_f32_16x16x32_bf16 v[68:71], a[12:15], a[140:143], v[68:71]
    buffer_load_dwordx4 v13, s[36:39], s61 offen offset:1024  lds
    v_mfma_f32_16x16x32_bf16 v[72:75], a[12:15], a[144:147], v[72:75]
    v_mfma_f32_16x16x32_bf16 v[76:79], a[12:15], a[148:151], v[76:79]
    v_mfma_f32_16x16x32_bf16 v[80:83], a[12:15], a[152:155], v[80:83]
    v_mfma_f32_16x16x32_bf16 v[84:87], a[12:15], a[156:159], v[84:87]
    buffer_store_dwordx4 v[132:135], v2, s[40:43], s71 offen offset:1024 sc1
    v_cvt_pk_bf16_f32 v136, v104, v105
    s_waitcnt lgkmcnt(2)
    v_mfma_f32_16x16x32_bf16 v[64:67], a[0:3], a[160:163], v[64:67]
    ds_read_b64_tr_b16 a[8:9], v19 offset:57344
    ds_read_b64_tr_b16 a[10:11], v19 offset:58368
    v_mfma_f32_16x16x32_bf16 v[68:71], a[0:3], a[164:167], v[68:71]
    v_cvt_pk_bf16_f32 v137, v106, v107
    v_cvt_pk_bf16_f32 v138, v108, v109
    v_mfma_f32_16x16x32_bf16 v[72:75], a[0:3], a[168:171], v[72:75]
    v_cvt_pk_bf16_f32 v139, v110, v111
    v_mfma_f32_16x16x32_bf16 v[76:79], a[0:3], a[172:175], v[76:79]
    buffer_load_dwordx4 v14, s[36:39], s61 offen offset:2048  lds
    v_mfma_f32_16x16x32_bf16 v[80:83], a[0:3], a[176:179], v[80:83]
    v_mfma_f32_16x16x32_bf16 v[84:87], a[0:3], a[180:183], v[84:87]
    s_waitcnt lgkmcnt(2)
    v_mfma_f32_16x16x32_bf16 v[64:67], a[4:7], a[184:187], v[64:67]
    ds_read_b64_tr_b16 a[12:13], v19 offset:61440
    ds_read_b64_tr_b16 a[14:15], v19 offset:62464
    v_mfma_f32_16x16x32_bf16 v[68:71], a[4:7], a[188:191], v[68:71]
    buffer_load_dwordx4 v15, s[36:39], s61 offen offset:3072  lds
    v_mfma_f32_16x16x32_bf16 v[72:75], a[4:7], a[192:195], v[72:75]
    v_mfma_f32_16x16x32_bf16 v[76:79], a[4:7], a[196:199], v[76:79]
    v_mfma_f32_16x16x32_bf16 v[80:83], a[4:7], a[200:203], v[80:83]
    v_mfma_f32_16x16x32_bf16 v[84:87], a[4:7], a[204:207], v[84:87]
    buffer_store_dwordx4 v[136:139], v2, s[40:43], s71 offen offset:2048 sc1
    s_waitcnt lgkmcnt(2)
    v_mfma_f32_16x16x32_bf16 v[64:67], a[8:11], a[208:211], v[64:67]
    v_mfma_f32_16x16x32_bf16 v[68:71], a[8:11], a[212:215], v[68:71]
    v_mfma_f32_16x16x32_bf16 v[72:75], a[8:11], a[216:219], v[72:75]
    v_mfma_f32_16x16x32_bf16 v[76:79], a[8:11], a[220:223], v[76:79]
    v_mfma_f32_16x16x32_bf16 v[80:83], a[8:11], a[224:227], v[80:83]
    v_mfma_f32_16x16x32_bf16 v[84:87], a[8:11], a[228:231], v[84:87]
    s_waitcnt lgkmcnt(0)
    s_waitcnt vmcnt(12)
    s_barrier
    v_mfma_f32_16x16x32_bf16 v[64:67], a[12:15], a[232:235], v[64:67]
    ds_read_b64_tr_b16 a[0:1], v19 offset:0
    ds_read_b64_tr_b16 a[2:3], v19 offset:1024
    v_mfma_f32_16x16x32_bf16 v[68:71], a[12:15], a[236:239], v[68:71]
    s_add_u32 m0, s52, 8192
    s_add_u32 s61, s55, s68
    buffer_load_dwordx4 v12, s[36:39], s61 offen offset:0  lds
    v_mfma_f32_16x16x32_bf16 v[72:75], a[12:15], a[240:243], v[72:75]
    ds_read_b64_tr_b16 a[4:5], v19 offset:4096
    ds_read_b64_tr_b16 a[6:7], v19 offset:5120
    v_mfma_f32_16x16x32_bf16 v[76:79], a[12:15], a[244:247], v[76:79]
    v_mfma_f32_16x16x32_bf16 v[80:83], a[12:15], a[248:251], v[80:83]
    v_mfma_f32_16x16x32_bf16 v[84:87], a[12:15], a[252:255], v[84:87]
    buffer_load_dwordx4 v13, s[36:39], s61 offen offset:1024  lds
    s_waitcnt lgkmcnt(2)
    v_mfma_f32_16x16x32_bf16 v[88:91], a[0:3], a[64:67], 0
    ds_read_b64_tr_b16 a[8:9], v19 offset:16384
    ds_read_b64_tr_b16 a[10:11], v19 offset:17408
    v_mfma_f32_16x16x32_bf16 v[92:95], a[0:3], a[68:71], 0
    v_mfma_f32_16x16x32_bf16 v[96:99], a[0:3], a[72:75], 0
    v_mfma_f32_16x16x32_bf16 v[100:103], a[0:3], a[76:79], 0
    buffer_load_dwordx4 v14, s[36:39], s61 offen offset:2048  lds
    v_cvt_pk_bf16_f32 v128, v64, v65
    v_mfma_f32_16x16x32_bf16 v[104:107], a[0:3], a[80:83], 0
    v_cvt_pk_bf16_f32 v129, v66, v67
    v_cvt_pk_bf16_f32 v130, v68, v69
    v_mfma_f32_16x16x32_bf16 v[108:111], a[0:3], a[84:87], 0
    v_cvt_pk_bf16_f32 v131, v70, v71
    s_add_u32 s71, s70, 36864
    s_waitcnt lgkmcnt(2)
    v_mfma_f32_16x16x32_bf16 v[88:91], a[4:7], a[88:91], v[88:91]
    ds_read_b64_tr_b16 a[12:13], v19 offset:20480
    ds_read_b64_tr_b16 a[14:15], v19 offset:21504
    v_mfma_f32_16x16x32_bf16 v[92:95], a[4:7], a[92:95], v[92:95]
    buffer_store_dwordx4 v[128:131], v2, s[40:43], s71 offen offset:0 sc1
    v_cvt_pk_bf16_f32 v132, v72, v73
    v_mfma_f32_16x16x32_bf16 v[96:99], a[4:7], a[96:99], v[96:99]
    v_cvt_pk_bf16_f32 v133, v74, v75
    v_cvt_pk_bf16_f32 v134, v76, v77
    v_mfma_f32_16x16x32_bf16 v[100:103], a[4:7], a[100:103], v[100:103]
    v_cvt_pk_bf16_f32 v135, v78, v79
    v_mfma_f32_16x16x32_bf16 v[104:107], a[4:7], a[104:107], v[104:107]
    v_mfma_f32_16x16x32_bf16 v[108:111], a[4:7], a[108:111], v[108:111]
    buffer_load_dwordx4 v15, s[36:39], s61 offen offset:3072  lds
    s_waitcnt lgkmcnt(2)
    v_mfma_f32_16x16x32_bf16 v[88:91], a[8:11], a[112:115], v[88:91]
    ds_read_b64_tr_b16 a[0:1], v19 offset:32768
    ds_read_b64_tr_b16 a[2:3], v19 offset:33792
    v_mfma_f32_16x16x32_bf16 v[92:95], a[8:11], a[116:119], v[92:95]
    v_mfma_f32_16x16x32_bf16 v[96:99], a[8:11], a[120:123], v[96:99]
    v_mfma_f32_16x16x32_bf16 v[100:103], a[8:11], a[124:127], v[100:103]
    s_add_u32 m0, s52, 12288
    s_add_u32 s61, s55, s68
    s_add_u32 s61, s61, 28672
    buffer_load_dwordx4 v12, s[36:39], s61 offen offset:0  lds
    v_mfma_f32_16x16x32_bf16 v[104:107], a[8:11], a[128:131], v[104:107]
    v_mfma_f32_16x16x32_bf16 v[108:111], a[8:11], a[132:135], v[108:111]
    s_waitcnt lgkmcnt(2)
    v_mfma_f32_16x16x32_bf16 v[88:91], a[12:15], a[136:139], v[88:91]
    ds_read_b64_tr_b16 a[4:5], v19 offset:36864
    ds_read_b64_tr_b16 a[6:7], v19 offset:37888
    v_mfma_f32_16x16x32_bf16 v[92:95], a[12:15], a[140:143], v[92:95]
    buffer_load_dwordx4 v13, s[36:39], s61 offen offset:1024  lds
    v_mfma_f32_16x16x32_bf16 v[96:99], a[12:15], a[144:147], v[96:99]
    v_mfma_f32_16x16x32_bf16 v[100:103], a[12:15], a[148:151], v[100:103]
    v_mfma_f32_16x16x32_bf16 v[104:107], a[12:15], a[152:155], v[104:107]
    v_mfma_f32_16x16x32_bf16 v[108:111], a[12:15], a[156:159], v[108:111]
    buffer_store_dwordx4 v[132:135], v2, s[40:43], s71 offen offset:1024 sc1
    v_cvt_pk_bf16_f32 v136, v80, v81
    s_waitcnt lgkmcnt(2)
    v_mfma_f32_16x16x32_bf16 v[88:91], a[0:3], a[160:163], v[88:91]
    ds_read_b64_tr_b16 a[8:9], v19 offset:49152
    ds_read_b64_tr_b16 a[10:11], v19 offset:50176
    v_mfma_f32_16x16x32_bf16 v[92:95], a[0:3], a[164:167], v[92:95]
    v_cvt_pk_bf16_f32 v137, v82, v83
    v_cvt_pk_bf16_f32 v138, v84, v85
    v_mfma_f32_16x16x32_bf16 v[96:99], a[0:3], a[168:171], v[96:99]
    v_cvt_pk_bf16_f32 v139, v86, v87
    v_mfma_f32_16x16x32_bf16 v[100:103], a[0:3], a[172:175], v[100:103]
    buffer_load_dwordx4 v14, s[36:39], s61 offen offset:2048  lds
    v_mfma_f32_16x16x32_bf16 v[104:107], a[0:3], a[176:179], v[104:107]
    v_mfma_f32_16x16x32_bf16 v[108:111], a[0:3], a[180:183], v[108:111]
    s_waitcnt lgkmcnt(2)
    v_mfma_f32_16x16x32_bf16 v[88:91], a[4:7], a[184:187], v[88:91]
    ds_read_b64_tr_b16 a[12:13], v19 offset:53248
    ds_read_b64_tr_b16 a[14:15], v19 offset:54272
    v_mfma_f32_16x16x32_bf16 v[92:95], a[4:7], a[188:191], v[92:95]
    buffer_load_dwordx4 v15, s[36:39], s61 offen offset:3072  lds
    v_mfma_f32_16x16x32_bf16 v[96:99], a[4:7], a[192:195], v[96:99]
    v_mfma_f32_16x16x32_bf16 v[100:103], a[4:7], a[196:199], v[100:103]
    v_mfma_f32_16x16x32_bf16 v[104:107], a[4:7], a[200:203], v[104:107]
    v_mfma_f32_16x16x32_bf16 v[108:111], a[4:7], a[204:207], v[108:111]
    buffer_store_dwordx4 v[136:139], v2, s[40:43], s71 offen offset:2048 sc1
    s_waitcnt lgkmcnt(2)
    v_mfma_f32_16x16x32_bf16 v[88:91], a[8:11], a[208:211], v[88:91]
    v_mfma_f32_16x16x32_bf16 v[92:95], a[8:11], a[212:215], v[92:95]
    v_mfma_f32_16x16x32_bf16 v[96:99], a[8:11], a[216:219], v[96:99]
    v_mfma_f32_16x16x32_bf16 v[100:103], a[8:11], a[220:223], v[100:103]
    v_mfma_f32_16x16x32_bf16 v[104:107], a[8:11], a[224:227], v[104:107]
    v_mfma_f32_16x16x32_bf16 v[108:111], a[8:11], a[228:231], v[108:111]
    s_waitcnt lgkmcnt(0)
    s_waitcnt vmcnt(12)
    s_barrier
    v_mfma_f32_16x16x32_bf16 v[88:91], a[12:15], a[232:235], v[88:91]
    ds_read_b64_tr_b16 a[0:1], v18 offset:0
    ds_read_b64_tr_b16 a[2:3], v18 offset:1024
    v_mfma_f32_16x16x32_bf16 v[92:95], a[12:15], a[236:239], v[92:95]
    v_mfma_f32_16x16x32_bf16 v[96:99], a[12:15], a[240:243], v[96:99]
    ds_read_b64_tr_b16 a[4:5], v18 offset:4096
    ds_read_b64_tr_b16 a[6:7], v18 offset:5120
    v_mfma_f32_16x16x32_bf16 v[100:103], a[12:15], a[244:247], v[100:103]
    v_mfma_f32_16x16x32_bf16 v[104:107], a[12:15], a[248:251], v[104:107]
    v_mfma_f32_16x16x32_bf16 v[108:111], a[12:15], a[252:255], v[108:111]
    s_waitcnt lgkmcnt(2)
    v_mfma_f32_16x16x32_bf16 v[64:67], a[0:3], a[64:67], 0
    ds_read_b64_tr_b16 a[8:9], v18 offset:8192
    ds_read_b64_tr_b16 a[10:11], v18 offset:9216
    v_mfma_f32_16x16x32_bf16 v[68:71], a[0:3], a[68:71], 0
    v_mfma_f32_16x16x32_bf16 v[72:75], a[0:3], a[72:75], 0
    v_mfma_f32_16x16x32_bf16 v[76:79], a[0:3], a[76:79], 0
    v_cvt_pk_bf16_f32 v128, v88, v89
    v_cvt_pk_bf16_f32 v129, v90, v91
    v_mfma_f32_16x16x32_bf16 v[80:83], a[0:3], a[80:83], 0
    v_cvt_pk_bf16_f32 v130, v92, v93
    v_cvt_pk_bf16_f32 v131, v94, v95
    v_mfma_f32_16x16x32_bf16 v[84:87], a[0:3], a[84:87], 0
    s_add_u32 s71, s70, 49152
    s_waitcnt lgkmcnt(2)
    v_mfma_f32_16x16x32_bf16 v[64:67], a[4:7], a[88:91], v[64:67]
    ds_read_b64_tr_b16 a[12:13], v18 offset:12288
    ds_read_b64_tr_b16 a[14:15], v18 offset:13312
    v_mfma_f32_16x16x32_bf16 v[68:71], a[4:7], a[92:95], v[68:71]
    buffer_store_dwordx4 v[128:131], v2, s[40:43], s71 offen offset:0 sc1
    v_cvt_pk_bf16_f32 v132, v96, v97
    v_mfma_f32_16x16x32_bf16 v[72:75], a[4:7], a[96:99], v[72:75]
    v_cvt_pk_bf16_f32 v133, v98, v99
    v_cvt_pk_bf16_f32 v134, v100, v101
    v_mfma_f32_16x16x32_bf16 v[76:79], a[4:7], a[100:103], v[76:79]
    v_cvt_pk_bf16_f32 v135, v102, v103
    v_mfma_f32_16x16x32_bf16 v[80:83], a[4:7], a[104:107], v[80:83]
    v_mfma_f32_16x16x32_bf16 v[84:87], a[4:7], a[108:111], v[84:87]
    s_waitcnt lgkmcnt(2)
    v_mfma_f32_16x16x32_bf16 v[64:67], a[8:11], a[112:115], v[64:67]
    ds_read_b64_tr_b16 a[0:1], v18 offset:16384
    ds_read_b64_tr_b16 a[2:3], v18 offset:17408
    v_mfma_f32_16x16x32_bf16 v[68:71], a[8:11], a[116:119], v[68:71]
    v_mfma_f32_16x16x32_bf16 v[72:75], a[8:11], a[120:123], v[72:75]
    v_mfma_f32_16x16x32_bf16 v[76:79], a[8:11], a[124:127], v[76:79]
    v_mfma_f32_16x16x32_bf16 v[80:83], a[8:11], a[128:131], v[80:83]
    v_mfma_f32_16x16x32_bf16 v[84:87], a[8:11], a[132:135], v[84:87]
    s_waitcnt lgkmcnt(2)
    v_mfma_f32_16x16x32_bf16 v[64:67], a[12:15], a[136:139], v[64:67]
    ds_read_b64_tr_b16 a[4:5], v18 offset:20480
    ds_read_b64_tr_b16 a[6:7], v18 offset:21504
    v_mfma_f32_16x16x32_bf16 v[68:71], a[12:15], a[140:143], v[68:71]
    v_mfma_f32_16x16x32_bf16 v[72:75], a[12:15], a[144:147], v[72:75]
    v_mfma_f32_16x16x32_bf16 v[76:79], a[12:15], a[148:151], v[76:79]
    v_mfma_f32_16x16x32_bf16 v[80:83], a[12:15], a[152:155], v[80:83]
    v_mfma_f32_16x16x32_bf16 v[84:87], a[12:15], a[156:159], v[84:87]
    buffer_store_dwordx4 v[132:135], v2, s[40:43], s71 offen offset:1024 sc1
    v_cvt_pk_bf16_f32 v136, v104, v105
    s_waitcnt lgkmcnt(2)
    v_mfma_f32_16x16x32_bf16 v[64:67], a[0:3], a[160:163], v[64:67]
    ds_read_b64_tr_b16 a[8:9], v18 offset:24576
    ds_read_b64_tr_b16 a[10:11], v18 offset:25600
    v_mfma_f32_16x16x32_bf16 v[68:71], a[0:3], a[164:167], v[68:71]
    v_cvt_pk_bf16_f32 v137, v106, v107
    v_cvt_pk_bf16_f32 v138, v108, v109
    v_mfma_f32_16x16x32_bf16 v[72:75], a[0:3], a[168:171], v[72:75]
    v_cvt_pk_bf16_f32 v139, v110, v111
    v_mfma_f32_16x16x32_bf16 v[76:79], a[0:3], a[172:175], v[76:79]
    v_mfma_f32_16x16x32_bf16 v[80:83], a[0:3], a[176:179], v[80:83]
    v_mfma_f32_16x16x32_bf16 v[84:87], a[0:3], a[180:183], v[84:87]
    s_waitcnt lgkmcnt(2)
    v_mfma_f32_16x16x32_bf16 v[64:67], a[4:7], a[184:187], v[64:67]
    ds_read_b64_tr_b16 a[12:13], v18 offset:28672
    ds_read_b64_tr_b16 a[14:15], v18 offset:29696
    v_mfma_f32_16x16x32_bf16 v[68:71], a[4:7], a[188:191], v[68:71]
    v_mfma_f32_16x16x32_bf16 v[72:75], a[4:7], a[192:195], v[72:75]
    v_mfma_f32_16x16x32_bf16 v[76:79], a[4:7], a[196:199], v[76:79]
    v_mfma_f32_16x16x32_bf16 v[80:83], a[4:7], a[200:203], v[80:83]
    v_mfma_f32_16x16x32_bf16 v[84:87], a[4:7], a[204:207], v[84:87]
    buffer_store_dwordx4 v[136:139], v2, s[40:43], s71 offen offset:2048 sc1
    s_waitcnt lgkmcnt(2)
    v_mfma_f32_16x16x32_bf16 v[64:67], a[8:11], a[208:211], v[64:67]
    v_mfma_f32_16x16x32_bf16 v[68:71], a[8:11], a[212:215], v[68:71]
    v_mfma_f32_16x16x32_bf16 v[72:75], a[8:11], a[216:219], v[72:75]
    v_mfma_f32_16x16x32_bf16 v[76:79], a[8:11], a[220:223], v[76:79]
    v_mfma_f32_16x16x32_bf16 v[80:83], a[8:11], a[224:227], v[80:83]
    v_mfma_f32_16x16x32_bf16 v[84:87], a[8:11], a[228:231], v[84:87]
    s_waitcnt lgkmcnt(0)
    s_waitcnt vmcnt(4)
    s_barrier
    v_mfma_f32_16x16x32_bf16 v[64:67], a[12:15], a[232:235], v[64:67]
    ds_read_b64_tr_b16 a[0:1], v19 offset:8192
    ds_read_b64_tr_b16 a[2:3], v19 offset:9216
    v_mfma_f32_16x16x32_bf16 v[68:71], a[12:15], a[236:239], v[68:71]
    v_mfma_f32_16x16x32_bf16 v[72:75], a[12:15], a[240:243], v[72:75]
    ds_read_b64_tr_b16 a[4:5], v19 offset:12288
    ds_read_b64_tr_b16 a[6:7], v19 offset:13312
    v_mfma_f32_16x16x32_bf16 v[76:79], a[12:15], a[244:247], v[76:79]
    v_mfma_f32_16x16x32_bf16 v[80:83], a[12:15], a[248:251], v[80:83]
    v_mfma_f32_16x16x32_bf16 v[84:87], a[12:15], a[252:255], v[84:87]
    s_waitcnt lgkmcnt(2)
    v_mfma_f32_16x16x32_bf16 v[88:91], a[0:3], a[64:67], 0
    ds_read_b64_tr_b16 a[8:9], v19 offset:24576
    ds_read_b64_tr_b16 a[10:11], v19 offset:25600
    v_mfma_f32_16x16x32_bf16 v[92:95], a[0:3], a[68:71], 0
    v_mfma_f32_16x16x32_bf16 v[96:99], a[0:3], a[72:75], 0
    v_mfma_f32_16x16x32_bf16 v[100:103], a[0:3], a[76:79], 0
    v_cvt_pk_bf16_f32 v128, v64, v65
    v_cvt_pk_bf16_f32 v129, v66, v67
    v_mfma_f32_16x16x32_bf16 v[104:107], a[0:3], a[80:83], 0
    v_cvt_pk_bf16_f32 v130, v68, v69
    v_cvt_pk_bf16_f32 v131, v70, v71
    v_mfma_f32_16x16x32_bf16 v[108:111], a[0:3], a[84:87], 0
    s_add_u32 s71, s70, 61440
    s_waitcnt lgkmcnt(2)
    v_mfma_f32_16x16x32_bf16 v[88:91], a[4:7], a[88:91], v[88:91]
    ds_read_b64_tr_b16 a[12:13], v19 offset:28672
    ds_read_b64_tr_b16 a[14:15], v19 offset:29696
    v_mfma_f32_16x16x32_bf16 v[92:95], a[4:7], a[92:95], v[92:95]
    buffer_store_dwordx4 v[128:131], v2, s[40:43], s71 offen offset:0 sc1
    v_cvt_pk_bf16_f32 v132, v72, v73
    v_mfma_f32_16x16x32_bf16 v[96:99], a[4:7], a[96:99], v[96:99]
    v_cvt_pk_bf16_f32 v133, v74, v75
    v_cvt_pk_bf16_f32 v134, v76, v77
    v_mfma_f32_16x16x32_bf16 v[100:103], a[4:7], a[100:103], v[100:103]
    v_cvt_pk_bf16_f32 v135, v78, v79
    v_mfma_f32_16x16x32_bf16 v[104:107], a[4:7], a[104:107], v[104:107]
    v_mfma_f32_16x16x32_bf16 v[108:111], a[4:7], a[108:111], v[108:111]
    s_waitcnt lgkmcnt(2)
    v_mfma_f32_16x16x32_bf16 v[88:91], a[8:11], a[112:115], v[88:91]
    ds_read_b64_tr_b16 a[0:1], v19 offset:40960
    ds_read_b64_tr_b16 a[2:3], v19 offset:41984
    v_mfma_f32_16x16x32_bf16 v[92:95], a[8:11], a[116:119], v[92:95]
    v_mfma_f32_16x16x32_bf16 v[96:99], a[8:11], a[120:123], v[96:99]
    v_mfma_f32_16x16x32_bf16 v[100:103], a[8:11], a[124:127], v[100:103]
    v_mfma_f32_16x16x32_bf16 v[104:107], a[8:11], a[128:131], v[104:107]
    v_mfma_f32_16x16x32_bf16 v[108:111], a[8:11], a[132:135], v[108:111]
    s_waitcnt lgkmcnt(2)
    v_mfma_f32_16x16x32_bf16 v[88:91], a[12:15], a[136:139], v[88:91]
    ds_read_b64_tr_b16 a[4:5], v19 offset:45056
    ds_read_b64_tr_b16 a[6:7], v19 offset:46080
    v_mfma_f32_16x16x32_bf16 v[92:95], a[12:15], a[140:143], v[92:95]
    v_mfma_f32_16x16x32_bf16 v[96:99], a[12:15], a[144:147], v[96:99]
    v_mfma_f32_16x16x32_bf16 v[100:103], a[12:15], a[148:151], v[100:103]
    v_mfma_f32_16x16x32_bf16 v[104:107], a[12:15], a[152:155], v[104:107]
    v_mfma_f32_16x16x32_bf16 v[108:111], a[12:15], a[156:159], v[108:111]
    buffer_store_dwordx4 v[132:135], v2, s[40:43], s71 offen offset:1024 sc1
    v_cvt_pk_bf16_f32 v136, v80, v81
    s_waitcnt lgkmcnt(2)
    v_mfma_f32_16x16x32_bf16 v[88:91], a[0:3], a[160:163], v[88:91]
    ds_read_b64_tr_b16 a[8:9], v19 offset:57344
    ds_read_b64_tr_b16 a[10:11], v19 offset:58368
    v_mfma_f32_16x16x32_bf16 v[92:95], a[0:3], a[164:167], v[92:95]
    v_cvt_pk_bf16_f32 v137, v82, v83
    v_cvt_pk_bf16_f32 v138, v84, v85
    v_mfma_f32_16x16x32_bf16 v[96:99], a[0:3], a[168:171], v[96:99]
    v_cvt_pk_bf16_f32 v139, v86, v87
    v_mfma_f32_16x16x32_bf16 v[100:103], a[0:3], a[172:175], v[100:103]
    v_mfma_f32_16x16x32_bf16 v[104:107], a[0:3], a[176:179], v[104:107]
    v_mfma_f32_16x16x32_bf16 v[108:111], a[0:3], a[180:183], v[108:111]
    s_waitcnt lgkmcnt(2)
    v_mfma_f32_16x16x32_bf16 v[88:91], a[4:7], a[184:187], v[88:91]
    ds_read_b64_tr_b16 a[12:13], v19 offset:61440
    ds_read_b64_tr_b16 a[14:15], v19 offset:62464
    v_mfma_f32_16x16x32_bf16 v[92:95], a[4:7], a[188:191], v[92:95]
    v_mfma_f32_16x16x32_bf16 v[96:99], a[4:7], a[192:195], v[96:99]
    v_mfma_f32_16x16x32_bf16 v[100:103], a[4:7], a[196:199], v[100:103]
    v_mfma_f32_16x16x32_bf16 v[104:107], a[4:7], a[200:203], v[104:107]
    v_mfma_f32_16x16x32_bf16 v[108:111], a[4:7], a[204:207], v[108:111]
    buffer_store_dwordx4 v[136:139], v2, s[40:43], s71 offen offset:2048 sc1
    s_waitcnt lgkmcnt(2)
    v_mfma_f32_16x16x32_bf16 v[88:91], a[8:11], a[208:211], v[88:91]
    v_mfma_f32_16x16x32_bf16 v[92:95], a[8:11], a[212:215], v[92:95]
    v_mfma_f32_16x16x32_bf16 v[96:99], a[8:11], a[216:219], v[96:99]
    v_mfma_f32_16x16x32_bf16 v[100:103], a[8:11], a[220:223], v[100:103]
    v_mfma_f32_16x16x32_bf16 v[104:107], a[8:11], a[224:227], v[104:107]
    v_mfma_f32_16x16x32_bf16 v[108:111], a[8:11], a[228:231], v[108:111]
    s_waitcnt lgkmcnt(0)
    v_mfma_f32_16x16x32_bf16 v[88:91], a[12:15], a[232:235], v[88:91]
    v_mfma_f32_16x16x32_bf16 v[92:95], a[12:15], a[236:239], v[92:95]
    v_mfma_f32_16x16x32_bf16 v[96:99], a[12:15], a[240:243], v[96:99]
    v_mfma_f32_16x16x32_bf16 v[100:103], a[12:15], a[244:247], v[100:103]
    v_mfma_f32_16x16x32_bf16 v[104:107], a[12:15], a[248:251], v[104:107]
    v_mfma_f32_16x16x32_bf16 v[108:111], a[12:15], a[252:255], v[108:111]
    s_nop 5
    v_cvt_pk_bf16_f32 v128, v88, v89
    v_cvt_pk_bf16_f32 v129, v90, v91
    v_cvt_pk_bf16_f32 v130, v92, v93
    v_cvt_pk_bf16_f32 v131, v94, v95
    s_add_u32 s71, s70, 73728
    buffer_store_dwordx4 v[128:131], v2, s[40:43], s71 offen offset:0 sc1
    v_cvt_pk_bf16_f32 v132, v96, v97
    v_cvt_pk_bf16_f32 v133, v98, v99
    v_cvt_pk_bf16_f32 v134, v100, v101
    v_cvt_pk_bf16_f32 v135, v102, v103
    buffer_store_dwordx4 v[132:135], v2, s[40:43], s71 offen offset:1024 sc1
    v_cvt_pk_bf16_f32 v136, v104, v105
    v_cvt_pk_bf16_f32 v137, v106, v107
    v_cvt_pk_bf16_f32 v138, v108, v109
    v_cvt_pk_bf16_f32 v139, v110, v111
    buffer_store_dwordx4 v[136:139], v2, s[40:43], s71 offen offset:2048 sc1
    v_and_b32 v16, 15, v1
    v_lshrrev_b32 v17, 4, v1
    v_and_b32 v18, 1, v16
    v_lshlrev_b32 v18, 4, v18
    v_mov_b32 v19, 0x3f80
    v_lshlrev_b32 v18, v18, v19
    v_bfe_u32 v19, v16, 1, 2
    v_lshrrev_b32 v20, 3, v16
    v_add_u32 v21, 2, v20
    v_mov_b32 v22, 0
    v_cmp_eq_u32 s[4:5], v17, v20
    v_cmp_eq_u32 s[6:7], v17, v21
    s_nop 1
    v_cndmask_b32 v23, v22, v18, s[4:5]
    v_cndmask_b32 v24, v22, v18, s[6:7]
    v_cmp_eq_u32 vcc, 0, v19
    s_nop 1
    v_cndmask_b32 v8, v22, v23, vcc
    v_cndmask_b32 v12, v22, v24, vcc
    v_cmp_eq_u32 vcc, 1, v19
    s_nop 1
    v_cndmask_b32 v9, v22, v23, vcc
    v_cndmask_b32 v13, v22, v24, vcc
    v_cmp_eq_u32 vcc, 2, v19
    s_nop 1
    v_cndmask_b32 v10, v22, v23, vcc
    v_cndmask_b32 v14, v22, v24, vcc
    v_cmp_eq_u32 vcc, 3, v19
    s_nop 1
    v_cndmask_b32 v11, v22, v23, vcc
    v_cndmask_b32 v15, v22, v24, vcc
    v_and_b32 v19, 1, v17
    v_lshl_add_u32 v19, v19, 4, v16
    v_mul_u32_u24 v19, 896, v19
    v_lshrrev_b32 v20, 1, v17
    v_lshl_add_u32 v4, v20, 3, v19
    s_mov_b32 s7, 0
    s_cmp_eq_u32 s48, 0
    s_cselect_b32 s7, 1, s7
    s_cmp_lt_u32 s50, 4
    s_cselect_b32 s8, 1, 0
    s_cmp_eq_u32 s48, 1
    s_cselect_b32 s8, s8, 0
    s_or_b32 s3, s7, s8
    s_lshl_b32 s8, s48, 4
    s_add_u32 s8, s8, s50
    s_mul_i32 s9, s49, 1376256
    s_lshl_b32 s11, s8, 10
    s_add_u32 s9, s9, s11
    s_mul_i32 s11, s8, 43691
    s_lshr_b32 s11, s11, 17
    s_mul_i32 s12, s11, 3
    s_sub_u32 s12, s8, s12
    s_lshr_b32 s15, s11, 2
    s_add_u32 s15, s15, s54
    s_cmp_ge_u32 s15, 7
    s_cselect_b32 s10, 7, 0
    s_sub_u32 s15, s15, s10
    s_and_b32 s11, s11, 3
    s_lshl_b32 s15, s15, 2
    s_add_u32 s11, s11, s15
    s_mul_i32 s13, s49, 96
    s_lshl_b32 s12, s12, 5
    s_add_u32 s13, s13, s12
    s_mul_i32 s13, s13, 896
    s_lshl_b32 s11, s11, 5
    s_add_u32 s13, s13, s11
    s_add_u32 s8, s8, 64
    s_mul_i32 s14, s49, 1376256
    s_lshl_b32 s11, s8, 10
    s_add_u32 s14, s14, s11
    s_mul_i32 s11, s8, 43691
    s_lshr_b32 s11, s11, 17
    s_mul_i32 s12, s11, 3
    s_sub_u32 s12, s8, s12
    s_lshr_b32 s15, s11, 2
    s_add_u32 s15, s15, s54
    s_cmp_ge_u32 s15, 7
    s_cselect_b32 s10, 7, 0
    s_sub_u32 s15, s15, s10
    s_and_b32 s11, s11, 3
    s_lshl_b32 s15, s15, 2
    s_add_u32 s11, s11, s15
    s_mul_i32 s18, s49, 96
    s_lshl_b32 s12, s12, 5
    s_add_u32 s18, s18, s12
    s_mul_i32 s18, s18, 896
    s_lshl_b32 s11, s11, 5
    s_add_u32 s18, s18, s11
    s_mul_i32 s56, s49, 8448
    s_add_u32 s56, s56, 33554432
    s_lshl_b32 s57, s50, 2
    v_lshlrev_b32 v32, 7, v1
    v_add_u32 v32, s57, v32
    v_mov_b32 v33, 1
    s_lshl_b32 s57, s50, 7
    v_and_b32 v34, 15, v1
    v_lshlrev_b32 v34, 2, v34
    v_add_u32 v34, s57, v34
    s_waitcnt vmcnt(0)
    s_barrier
    s_cmp_lg_u32 s48, 0
    s_cbranch_scc1 L_nopoll
    v_readfirstlane_b32 s6, v44
    s_cmp_lg_u32 s48, 0
    s_cbranch_scc1 L_rdyokT
    s_cmp_eq_u32 s6, 1
    s_cbranch_scc1 L_rdyokT
    s_lshl_b32 s58, s49, 4
    v_mov_b32 v62, s58
    s_mov_b32 s7, 0x400000
L_rdyT:
    global_load_dword v61, v62, s[16:17] sc1
    s_waitcnt vmcnt(0)
    v_readfirstlane_b32 s6, v61
    s_sub_u32 s7, s7, 1
    s_cmp_eq_u32 s7, 0
    s_cbranch_scc1 L_rdyokT
    s_cmp_eq_u32 s6, 1
    s_cbranch_scc0 L_rdyT
L_rdyokT:
    s_mov_b64 exec, 0xffff
    buffer_store_dword v33, v32, s[40:43], s56 offen sc1
    s_mov_b64 exec, -1
    s_mov_b32 s6, 0x400000
L_pollS:
    buffer_load_dword v56, v34, s[40:43], s56 offen sc1
    s_waitcnt vmcnt(0)
    v_cmp_ne_u32 vcc, 1, v56
    s_cbranch_vccz L_pokS
    s_sub_u32 s6, s6, 1
    s_cmp_eq_u32 s6, 0
    s_cbranch_scc0 L_pollS
L_pokS:
L_nopoll:
    s_barrier
    s_cmp_eq_u32 s3, 0
    s_cbranch_scc1 L_oneM
    buffer_load_dwordx4 v[64:67], v2, s[40:43], s9 offen sc1
    s_add_u32 s9, s9, 86016
    buffer_load_dwordx4 v[68:71], v2, s[40:43], s9 offen sc1
    s_add_u32 s9, s9, 86016
    buffer_load_dwordx4 v[72:75], v2, s[40:43], s9 offen sc1
    s_add_u32 s9, s9, 86016
    buffer_load_dwordx4 v[76:79], v2, s[40:43], s9 offen sc1
    s_add_u32 s9, s9, 86016
    buffer_load_dwordx4 v[80:83], v2, s[40:43], s9 offen sc1
    s_add_u32 s9, s9, 86016
    buffer_load_dwordx4 v[84:87], v2, s[40:43], s9 offen sc1
    s_add_u32 s9, s9, 86016
    buffer_load_dwordx4 v[88:91], v2, s[40:43], s9 offen sc1
    s_add_u32 s9, s9, 86016
    buffer_load_dwordx4 v[92:95], v2, s[40:43], s9 offen sc1
    s_add_u32 s9, s9, 86016
    buffer_load_dwordx4 v[96:99], v2, s[40:43], s9 offen sc1
    s_add_u32 s9, s9, 86016
    buffer_load_dwordx4 v[100:103], v2, s[40:43], s9 offen sc1
    s_add_u32 s9, s9, 86016
    buffer_load_dwordx4 v[104:107], v2, s[40:43], s9 offen sc1
    s_add_u32 s9, s9, 86016
    buffer_load_dwordx4 v[108:111], v2, s[40:43], s9 offen sc1
    s_add_u32 s9, s9, 86016
    buffer_load_dwordx4 v[112:115], v2, s[40:43], s9 offen sc1
    s_add_u32 s9, s9, 86016
    buffer_load_dwordx4 v[116:119], v2, s[40:43], s9 offen sc1
    s_add_u32 s9, s9, 86016
    buffer_load_dwordx4 v[120:123], v2, s[40:43], s9 offen sc1
    s_add_u32 s9, s9, 86016
    buffer_load_dwordx4 v[124:127], v2, s[40:43], s9 offen sc1
    buffer_load_dwordx4 v[128:131], v2, s[40:43], s14 offen sc1
    s_add_u32 s14, s14, 86016
    buffer_load_dwordx4 v[132:135], v2, s[40:43], s14 offen sc1
    s_add_u32 s14, s14, 86016
    buffer_load_dwordx4 v[136:139], v2, s[40:43], s14 offen sc1
    s_add_u32 s14, s14, 86016
    buffer_load_dwordx4 v[140:143], v2, s[40:43], s14 offen sc1
    s_add_u32 s14, s14, 86016
    buffer_load_dwordx4 v[144:147], v2, s[40:43], s14 offen sc1
    s_add_u32 s14, s14, 86016
    buffer_load_dwordx4 v[148:151], v2, s[40:43], s14 offen sc1
    s_add_u32 s14, s14, 86016
    buffer_load_dwordx4 v[152:155], v2, s[40:43], s14 offen sc1
    s_add_u32 s14, s14, 86016
    buffer_load_dwordx4 v[156:159], v2, s[40:43], s14 offen sc1
    s_add_u32 s14, s14, 86016
    buffer_load_dwordx4 v[160:163], v2, s[40:43], s14 offen sc1
    s_add_u32 s14, s14, 86016
    buffer_load_dwordx4 v[164:167], v2, s[40:43], s14 offen sc1
    s_add_u32 s14, s14, 86016
    buffer_load_dwordx4 v[168:171], v2, s[40:43], s14 offen sc1
    s_add_u32 s14, s14, 86016
    buffer_load_dwordx4 v[172:175], v2, s[40:43], s14 offen sc1
    s_add_u32 s14, s14, 86016
    buffer_load_dwordx4 v[176:179], v2, s[40:43], s14 offen sc1
    s_add_u32 s14, s14, 86016
    buffer_load_dwordx4 v[180:183], v2, s[40:43], s14 offen sc1
    s_add_u32 s14, s14, 86016
    buffer_load_dwordx4 v[184:187], v2, s[40:43], s14 offen sc1
    s_add_u32 s14, s14, 86016
    buffer_load_dwordx4 v[188:191], v2, s[40:43], s14 offen sc1
    s_waitcnt vmcnt(31)
    v_mfma_f32_16x16x32_bf16 v[24:27], v[8:11], v[64:67], 0
    v_mfma_f32_16x16x32_bf16 v[28:31], v[12:15], v[64:67], 0
    s_waitcnt vmcnt(30)
    v_mfma_f32_16x16x32_bf16 v[24:27], v[8:11], v[68:71], v[24:27]
    v_mfma_f32_16x16x32_bf16 v[28:31], v[12:15], v[68:71], v[28:31]
    s_waitcnt vmcnt(29)
    v_mfma_f32_16x16x32_bf16 v[24:27], v[8:11], v[72:75], v[24:27]
    v_mfma_f32_16x16x32_bf16 v[28:31], v[12:15], v[72:75], v[28:31]
    s_waitcnt vmcnt(28)
    v_mfma_f32_16x16x32_bf16 v[24:27], v[8:11], v[76:79], v[24:27]
    v_mfma_f32_16x16x32_bf16 v[28:31], v[12:15], v[76:79], v[28:31]
    s_waitcnt vmcnt(27)
    v_mfma_f32_16x16x32_bf16 v[24:27], v[8:11], v[80:83], v[24:27]
    v_mfma_f32_16x16x32_bf16 v[28:31], v[12:15], v[80:83], v[28:31]
    s_waitcnt vmcnt(26)
    v_mfma_f32_16x16x32_bf16 v[24:27], v[8:11], v[84:87], v[24:27]
    v_mfma_f32_16x16x32_bf16 v[28:31], v[12:15], v[84:87], v[28:31]
    s_waitcnt vmcnt(25)
    v_mfma_f32_16x16x32_bf16 v[24:27], v[8:11], v[88:91], v[24:27]
    v_mfma_f32_16x16x32_bf16 v[28:31], v[12:15], v[88:91], v[28:31]
    s_waitcnt vmcnt(24)
    v_mfma_f32_16x16x32_bf16 v[24:27], v[8:11], v[92:95], v[24:27]
    v_mfma_f32_16x16x32_bf16 v[28:31], v[12:15], v[92:95], v[28:31]
    s_waitcnt vmcnt(23)
    v_mfma_f32_16x16x32_bf16 v[24:27], v[8:11], v[96:99], v[24:27]
    v_mfma_f32_16x16x32_bf16 v[28:31], v[12:15], v[96:99], v[28:31]
    s_waitcnt vmcnt(22)
    v_mfma_f32_16x16x32_bf16 v[24:27], v[8:11], v[100:103], v[24:27]
    v_mfma_f32_16x16x32_bf16 v[28:31], v[12:15], v[100:103], v[28:31]
    s_waitcnt vmcnt(21)
    v_mfma_f32_16x16x32_bf16 v[24:27], v[8:11], v[104:107], v[24:27]
    v_mfma_f32_16x16x32_bf16 v[28:31], v[12:15], v[104:107], v[28:31]
    s_waitcnt vmcnt(20)
    v_mfma_f32_16x16x32_bf16 v[24:27], v[8:11], v[108:111], v[24:27]
    v_mfma_f32_16x16x32_bf16 v[28:31], v[12:15], v[108:111], v[28:31]
    s_waitcnt vmcnt(19)
    v_mfma_f32_16x16x32_bf16 v[24:27], v[8:11], v[112:115], v[24:27]
    v_mfma_f32_16x16x32_bf16 v[28:31], v[12:15], v[112:115], v[28:31]
    s_waitcnt vmcnt(18)
    v_mfma_f32_16x16x32_bf16 v[24:27], v[8:11], v[116:119], v[24:27]
    v_mfma_f32_16x16x32_bf16 v[28:31], v[12:15], v[116:119], v[28:31]
    s_waitcnt vmcnt(17)
    v_mfma_f32_16x16x32_bf16 v[24:27], v[8:11], v[120:123], v[24:27]
    v_mfma_f32_16x16x32_bf16 v[28:31], v[12:15], v[120:123], v[28:31]
    s_waitcnt vmcnt(16)
    v_mfma_f32_16x16x32_bf16 v[24:27], v[8:11], v[124:127], v[24:27]
    v_mfma_f32_16x16x32_bf16 v[28:31], v[12:15], v[124:127], v[28:31]
    s_nop 7
    v_cvt_pk_bf16_f32 v32, v24, v25
    v_cvt_pk_bf16_f32 v33, v26, v27
    v_cvt_pk_bf16_f32 v34, v28, v29
    v_cvt_pk_bf16_f32 v35, v30, v31
    buffer_store_dwordx2 v[32:33], v4, s[44:47], s13 offen offset:0
    buffer_store_dwordx2 v[34:35], v4, s[44:47], s13 offen offset:16
    s_waitcnt vmcnt(17)
    v_mfma_f32_16x16x32_bf16 v[40:43], v[8:11], v[128:131], 0
    v_mfma_f32_16x16x32_bf16 v[44:47], v[12:15], v[128:131], 0
    s_waitcnt vmcnt(16)
    v_mfma_f32_16x16x32_bf16 v[40:43], v[8:11], v[132:135], v[40:43]
    v_mfma_f32_16x16x32_bf16 v[44:47], v[12:15], v[132:135], v[44:47]
    s_waitcnt vmcnt(15)
    v_mfma_f32_16x16x32_bf16 v[40:43], v[8:11], v[136:139], v[40:43]
    v_mfma_f32_16x16x32_bf16 v[44:47], v[12:15], v[136:139], v[44:47]
    s_waitcnt vmcnt(14)
    v_mfma_f32_16x16x32_bf16 v[40:43], v[8:11], v[140:143], v[40:43]
    v_mfma_f32_16x16x32_bf16 v[44:47], v[12:15], v[140:143], v[44:47]
    s_waitcnt vmcnt(13)
    v_mfma_f32_16x16x32_bf16 v[40:43], v[8:11], v[144:147], v[40:43]
    v_mfma_f32_16x16x32_bf16 v[44:47], v[12:15], v[144:147], v[44:47]
    s_waitcnt vmcnt(12)
    v_mfma_f32_16x16x32_bf16 v[40:43], v[8:11], v[148:151], v[40:43]
    v_mfma_f32_16x16x32_bf16 v[44:47], v[12:15], v[148:151], v[44:47]
    s_waitcnt vmcnt(11)
    v_mfma_f32_16x16x32_bf16 v[40:43], v[8:11], v[152:155], v[40:43]
    v_mfma_f32_16x16x32_bf16 v[44:47], v[12:15], v[152:155], v[44:47]
    s_waitcnt vmcnt(10)
    v_mfma_f32_16x16x32_bf16 v[40:43], v[8:11], v[156:159], v[40:43]
    v_mfma_f32_16x16x32_bf16 v[44:47], v[12:15], v[156:159], v[44:47]
    s_waitcnt vmcnt(9)
    v_mfma_f32_16x16x32_bf16 v[40:43], v[8:11], v[160:163], v[40:43]
    v_mfma_f32_16x16x32_bf16 v[44:47], v[12:15], v[160:163], v[44:47]
    s_waitcnt vmcnt(8)
    v_mfma_f32_16x16x32_bf16 v[40:43], v[8:11], v[164:167], v[40:43]
    v_mfma_f32_16x16x32_bf16 v[44:47], v[12:15], v[164:167], v[44:47]
    s_waitcnt vmcnt(7)
    v_mfma_f32_16x16x32_bf16 v[40:43], v[8:11], v[168:171], v[40:43]
    v_mfma_f32_16x16x32_bf16 v[44:47], v[12:15], v[168:171], v[44:47]
    s_waitcnt vmcnt(6)
    v_mfma_f32_16x16x32_bf16 v[40:43], v[8:11], v[172:175], v[40:43]
    v_mfma_f32_16x16x32_bf16 v[44:47], v[12:15], v[172:175], v[44:47]
    s_waitcnt vmcnt(5)
    v_mfma_f32_16x16x32_bf16 v[40:43], v[8:11], v[176:179], v[40:43]
    v_mfma_f32_16x16x32_bf16 v[44:47], v[12:15], v[176:179], v[44:47]
    s_waitcnt vmcnt(4)
    v_mfma_f32_16x16x32_bf16 v[40:43], v[8:11], v[180:183], v[40:43]
    v_mfma_f32_16x16x32_bf16 v[44:47], v[12:15], v[180:183], v[44:47]
    s_waitcnt vmcnt(3)
    v_mfma_f32_16x16x32_bf16 v[40:43], v[8:11], v[184:187], v[40:43]
    v_mfma_f32_16x16x32_bf16 v[44:47], v[12:15], v[184:187], v[44:47]
    s_waitcnt vmcnt(2)
    v_mfma_f32_16x16x32_bf16 v[40:43], v[8:11], v[188:191], v[40:43]
    v_mfma_f32_16x16x32_bf16 v[44:47], v[12:15], v[188:191], v[44:47]
    s_nop 7
    v_cvt_pk_bf16_f32 v48, v40, v41
    v_cvt_pk_bf16_f32 v49, v42, v43
    v_cvt_pk_bf16_f32 v50, v44, v45
    v_cvt_pk_bf16_f32 v51, v46, v47
    buffer_store_dwordx2 v[48:49], v4, s[44:47], s18 offen offset:0
    buffer_store_dwordx2 v[50:51], v4, s[44:47], s18 offen offset:16
    s_branch L_doneM
L_oneM:
    buffer_load_dwordx4 v[64:67], v2, s[40:43], s9 offen sc1
    s_add_u32 s9, s9, 86016
    buffer_load_dwordx4 v[68:71], v2, s[40:43], s9 offen sc1
    s_add_u32 s9, s9, 86016
    buffer_load_dwordx4 v[72:75], v2, s[40:43], s9 offen sc1
    s_add_u32 s9, s9, 86016
    buffer_load_dwordx4 v[76:79], v2, s[40:43], s9 offen sc1
    s_add_u32 s9, s9, 86016
    buffer_load_dwordx4 v[80:83], v2, s[40:43], s9 offen sc1
    s_add_u32 s9, s9, 86016
    buffer_load_dwordx4 v[84:87], v2, s[40:43], s9 offen sc1
    s_add_u32 s9, s9, 86016
    buffer_load_dwordx4 v[88:91], v2, s[40:43], s9 offen sc1
    s_add_u32 s9, s9, 86016
    buffer_load_dwordx4 v[92:95], v2, s[40:43], s9 offen sc1
    s_add_u32 s9, s9, 86016
    buffer_load_dwordx4 v[96:99], v2, s[40:43], s9 offen sc1
    s_add_u32 s9, s9, 86016
    buffer_load_dwordx4 v[100:103], v2, s[40:43], s9 offen sc1
    s_add_u32 s9, s9, 86016
    buffer_load_dwordx4 v[104:107], v2, s[40:43], s9 offen sc1
    s_add_u32 s9, s9, 86016
    buffer_load_dwordx4 v[108:111], v2, s[40:43], s9 offen sc1
    s_add_u32 s9, s9, 86016
    buffer_load_dwordx4 v[112:115], v2, s[40:43], s9 offen sc1
    s_add_u32 s9, s9, 86016
    buffer_load_dwordx4 v[116:119], v2, s[40:43], s9 offen sc1
    s_add_u32 s9, s9, 86016
    buffer_load_dwordx4 v[120:123], v2, s[40:43], s9 offen sc1
    s_add_u32 s9, s9, 86016
    buffer_load_dwordx4 v[124:127], v2, s[40:43], s9 offen sc1
    s_waitcnt vmcnt(15)
    v_mfma_f32_16x16x32_bf16 v[24:27], v[8:11], v[64:67], 0
    v_mfma_f32_16x16x32_bf16 v[28:31], v[12:15], v[64:67], 0
    s_waitcnt vmcnt(14)
    v_mfma_f32_16x16x32_bf16 v[24:27], v[8:11], v[68:71], v[24:27]
    v_mfma_f32_16x16x32_bf16 v[28:31], v[12:15], v[68:71], v[28:31]
    s_waitcnt vmcnt(13)
    v_mfma_f32_16x16x32_bf16 v[24:27], v[8:11], v[72:75], v[24:27]
    v_mfma_f32_16x16x32_bf16 v[28:31], v[12:15], v[72:75], v[28:31]
    s_waitcnt vmcnt(12)
    v_mfma_f32_16x16x32_bf16 v[24:27], v[8:11], v[76:79], v[24:27]
    v_mfma_f32_16x16x32_bf16 v[28:31], v[12:15], v[76:79], v[28:31]
    s_waitcnt vmcnt(11)
    v_mfma_f32_16x16x32_bf16 v[24:27], v[8:11], v[80:83], v[24:27]
    v_mfma_f32_16x16x32_bf16 v[28:31], v[12:15], v[80:83], v[28:31]
    s_waitcnt vmcnt(10)
    v_mfma_f32_16x16x32_bf16 v[24:27], v[8:11], v[84:87], v[24:27]
    v_mfma_f32_16x16x32_bf16 v[28:31], v[12:15], v[84:87], v[28:31]
    s_waitcnt vmcnt(9)
    v_mfma_f32_16x16x32_bf16 v[24:27], v[8:11], v[88:91], v[24:27]
    v_mfma_f32_16x16x32_bf16 v[28:31], v[12:15], v[88:91], v[28:31]
    s_waitcnt vmcnt(8)
    v_mfma_f32_16x16x32_bf16 v[24:27], v[8:11], v[92:95], v[24:27]
    v_mfma_f32_16x16x32_bf16 v[28:31], v[12:15], v[92:95], v[28:31]
    s_waitcnt vmcnt(7)
    v_mfma_f32_16x16x32_bf16 v[24:27], v[8:11], v[96:99], v[24:27]
    v_mfma_f32_16x16x32_bf16 v[28:31], v[12:15], v[96:99], v[28:31]
    s_waitcnt vmcnt(6)
    v_mfma_f32_16x16x32_bf16 v[24:27], v[8:11], v[100:103], v[24:27]
    v_mfma_f32_16x16x32_bf16 v[28:31], v[12:15], v[100:103], v[28:31]
    s_waitcnt vmcnt(5)
    v_mfma_f32_16x16x32_bf16 v[24:27], v[8:11], v[104:107], v[24:27]
    v_mfma_f32_16x16x32_bf16 v[28:31], v[12:15], v[104:107], v[28:31]
    s_waitcnt vmcnt(4)
    v_mfma_f32_16x16x32_bf16 v[24:27], v[8:11], v[108:111], v[24:27]
    v_mfma_f32_16x16x32_bf16 v[28:31], v[12:15], v[108:111], v[28:31]
    s_waitcnt vmcnt(3)
    v_mfma_f32_16x16x32_bf16 v[24:27], v[8:11], v[112:115], v[24:27]
    v_mfma_f32_16x16x32_bf16 v[28:31], v[12:15], v[112:115], v[28:31]
    s_waitcnt vmcnt(2)
    v_mfma_f32_16x16x32_bf16 v[24:27], v[8:11], v[116:119], v[24:27]
    v_mfma_f32_16x16x32_bf16 v[28:31], v[12:15], v[116:119], v[28:31]
    s_waitcnt vmcnt(1)
    v_mfma_f32_16x16x32_bf16 v[24:27], v[8:11], v[120:123], v[24:27]
    v_mfma_f32_16x16x32_bf16 v[28:31], v[12:15], v[120:123], v[28:31]
    s_waitcnt vmcnt(0)
    v_mfma_f32_16x16x32_bf16 v[24:27], v[8:11], v[124:127], v[24:27]
    v_mfma_f32_16x16x32_bf16 v[28:31], v[12:15], v[124:127], v[28:31]
    s_nop 7
    v_cvt_pk_bf16_f32 v32, v24, v25
    v_cvt_pk_bf16_f32 v33, v26, v27
    v_cvt_pk_bf16_f32 v34, v28, v29
    v_cvt_pk_bf16_f32 v35, v30, v31
    buffer_store_dwordx2 v[32:33], v4, s[44:47], s13 offen offset:0
    buffer_store_dwordx2 v[34:35], v4, s[44:47], s13 offen offset:16
L_doneM:
L_end:
    s_endpgm
.section .rodata,"a"
.p2align 6
.amdhsa_kernel standalone__gqa_block_cached__near_ridge_kernel
  .amdhsa_next_free_vgpr 512
  .amdhsa_next_free_sgpr 102
  .amdhsa_accum_offset 256
  .amdhsa_group_segment_fixed_size 0
  .amdhsa_kernarg_size 64
  .amdhsa_user_sgpr_count 2
  .amdhsa_user_sgpr_kernarg_segment_ptr 1
  .amdhsa_system_sgpr_workgroup_id_x 1
  .amdhsa_float_denorm_mode_32 3
.end_amdhsa_kernel
```
